```python
import torch

def _softmax(x, axis=-1):
    return torch.softmax(x, dim=axis)
def _gelu(x):
    return torch.nn.functional.gelu(x, approximate="tanh")
def _silu(x):
    return torch.nn.functional.silu(x)
def _sigmoid(x):
    return torch.sigmoid(x)
def _layernorm(x, axis=-1, eps=1e-5):
    m = x.mean(dim=axis, keepdim=True)
    v = x.var(dim=axis, keepdim=True, unbiased=False)
    return (x - m) / torch.sqrt(v + eps)
def _scatter_add(tgt, idx, src, axis=0):
    return tgt.clone().index_add_(axis, idx, src)
def _segment_sum(src, seg, n):
    out = torch.zeros((n,) + src.shape[1:], dtype=src.dtype)
    return out.index_add_(0, seg, src)
def _pad(x, pw):
    flat = tuple(v for pair in reversed(pw) for v in pair)
    return torch.nn.functional.pad(x, flat)

kernel_name = 'sequential_preLN__sliding_block_cached__moe_arch_mod__decode'

def setup_inputs():

    _w = (lambda a: (lambda t: t.to(torch.bfloat16) if t.is_floating_point() else t)(torch.as_tensor(a)))
    def _A_setup():
        B, Sq, D = 8, 1, 640
        Hq, Hkv, Sk, Dh = 32, 32, 4096, 128
        assert Hq % Hkv == 0, (Hq, Hkv)
        return {
            "x": _w((lambda *s: torch.randn(*s, dtype=torch.bfloat16) * 0.1)(B, Sq, D)),
            "k_cache": _w((lambda *s: torch.randn(*s, dtype=torch.bfloat16) * 0.8)(B, Hkv, Sk, Dh)),
            "v_cache": _w((lambda *s: torch.randn(*s, dtype=torch.bfloat16) * 1.6)(B, Hkv, Sk, Dh)),
            "wq": _w((lambda *s: torch.randn(*s, dtype=torch.bfloat16) * 0.8)(D, Hq * Dh) * (D ** -0.5)),
            "wo": _w((lambda *s: torch.randn(*s, dtype=torch.bfloat16) * 1.6)(Hq * Dh, D) * ((Hq * Dh) ** -0.5)),
        }
    _A_in = _A_setup()

    def _B_setup():
        B, S, D, F, C = 8, 1, 640, 1728, 1
        return {
            "x": _w((lambda *s: torch.randn(*s, dtype=torch.bfloat16) * 0.1)(B, S, D)),
            "w_r": _w((lambda *s: torch.randn(*s, dtype=torch.bfloat16) * 3.2)(D)),
            "w_gate": _w((lambda *s: torch.randn(*s, dtype=torch.bfloat16) * 0.2)(D, F)),
            "w_up": _w((lambda *s: torch.randn(*s, dtype=torch.bfloat16) * 0.2)(D, F)),
            "w_down": _w((lambda *s: torch.randn(*s, dtype=torch.bfloat16) * 0.2)(F, D)),
        }
    _B_in = _B_setup()

    return {
        "A_x": _A_in["x"],
        "A_k_cache": _A_in["k_cache"],
        "A_v_cache": _A_in["v_cache"],
        "A_wq": _A_in["wq"],
        "A_wo": _A_in["wo"],
        "B_x": _B_in["x"],
        "B_w_r": _B_in["w_r"],
        "B_w_gate": _B_in["w_gate"],
        "B_w_up": _B_in["w_up"],
        "B_w_down": _B_in["w_down"],
    }

def reference(A_x, A_k_cache, A_v_cache, A_wq, A_wo, B_x, B_w_r, B_w_gate, B_w_up, B_w_down):
    def _A_ref(x, k_cache, v_cache, wq, wo):
        B, Sq, D = x.shape
        Hq, Dh = 32, 128
        Hkv, Sk = k_cache.shape[1], k_cache.shape[2]
        W = min(4096, max(256, Sk // 4))
        rep = Hq // Hkv
        q = (lambda x, *d: x.permute(*d))((x @ wq).reshape(B, Sq, Hq, Dh), 0, 2, 1, 3)
        k = (lambda x, n, axis: torch.repeat_interleave(x, n, dim=axis))(k_cache[:, :, Sk - W:, :], rep, axis=1)
        v = (lambda x, n, axis: torch.repeat_interleave(x, n, dim=axis))(v_cache[:, :, Sk - W:, :], rep, axis=1)
        scores = torch.einsum("bhqd,bhkd->bhqk", q, k) * (Dh ** -0.5)
        p = _softmax(scores, axis=-1)
        o = torch.einsum("bhqk,bhkd->bhqd", p, v)
        return (lambda x, *d: x.permute(*d))(o, 0, 2, 1, 3).reshape(B, Sq, Hq * Dh) @ wo

    def _B_ref(x, w_r, w_gate, w_up, w_down):
        B, S, D = x.shape
        C = 1
        r = x @ w_r
        idx = torch.argsort(-r, axis=-1)[:, :C]
        idx_e = (lambda x, n, axis: torch.repeat_interleave(x, n, dim=axis))(idx.reshape(B, C, 1), D, axis=2)
        x_sel = (lambda x, i, axis: torch.take_along_dim(x, i, dim=axis))(x, idx_e, axis=1)
        g = _silu(x_sel @ w_gate)
        u = x_sel @ w_up
        y = (g * u) @ w_down
        r_sel = _sigmoid((lambda x, i, axis: torch.take_along_dim(x, i, dim=axis))(r, idx, axis=1))
        y = y * r_sel.reshape(B, C, 1)
        b_off = (torch.arange(B) * S).reshape(B, 1)
        flat_idx = (idx + b_off).reshape(B * C)
        zero = (x * 0.0).reshape(B * S, D)
        upd = _scatter_add(zero, flat_idx, y.reshape(B * C, D), axis=0)
        return x + upd.reshape(B, S, D)

    x = A_x
    h = x + _A_ref(_layernorm(x, axis=-1), A_k_cache, A_v_cache, A_wq, A_wo)
    h2 = h + _B_ref(_layernorm(h, axis=-1), B_w_r, B_w_gate, B_w_up, B_w_down)
    return h2
```

```asm
; @launch grid=(256,1,1) block=(512,1,1) lds=116736
.amdgcn_target "amdgcn-amd-amdhsa--gfx950"
.text
.globl sequential_preLN__sliding_block_cached__moe_arch_mod__decode_kernel
.p2align 8
.type sequential_preLN__sliding_block_cached__moe_arch_mod__decode_kernel,@function
sequential_preLN__sliding_block_cached__moe_arch_mod__decode_kernel:
    s_cmpk_ge_u32 s2, 0x100
    s_cbranch_scc1 L_end
    s_load_dwordx16 s[16:31], s[0:1], 0
    s_lshr_b32 s11, s2, 2
    s_xor_b32 s11, s11, s2
    s_and_b32 s11, s11, 2
    s_mul_i32 s11, s11, 5
    s_xor_b32 s3, s2, s11
    s_lshl2_add_u32 s13, s3, 3
    s_lshl_b32 s13, s13, 18
    v_and_b32 v2, 0x1cc, v0
    v_and_b32 v5, 3, v0
    v_and_b32 v7, 48, v0
    v_lshl_add_u32 v2, v2, 6, s13
    v_lshl_add_u32 v2, v5, 4, v2
    v_lshl_add_u32 v2, v7, 2, v2
    v_and_b32 v3, 64, v0
    v_lshl_add_u32 v2, v3, 11, v2
    s_waitcnt lgkmcnt(0)
    global_load_dwordx4 v[128:131], v2, s[18:19] offset:0 nt
    global_load_dwordx4 v[132:135], v2, s[18:19] offset:1024 nt
    global_load_dwordx4 v[136:139], v2, s[18:19] offset:2048 nt
    s_load_dwordx8 s[32:39], s[0:1], 64
    s_load_dwordx2 s[40:41], s[0:1], 96
    v_lshrrev_b32 v6, 6, v0
    v_and_b32 v1, 63, v0
    s_and_b32 s10, s2, 7
    v_readfirstlane_b32 s5, v6
    s_and_b32 s3, s3, 31
    s_lshr_b32 s4, s2, 5
    v_lshlrev_b32 v44, 4, v1
    v_bfe_u32 v46, v0, 4, 2
    v_mul_u32_u24 v20, 1280, v6
    v_lshl_add_u32 v21, v1, 2, v20
    v_add_u32 v20, v20, v44
    global_load_dwordx4 v[28:31], v20, s[16:17]
    global_load_dword v32, v21, s[16:17] offset:1024
    v_lshl_add_u32 v3, v3, 11, v44
    v_lshl_add_u32 v3, v6, 12, v3
    v_add_u32 v3, s13, v3
    v_and_b32 v47, 15, v0
    v_and_b32 v24, 1, v6
    v_lshlrev_b32 v24, 3, v24
    v_lshl_add_u32 v24, v46, 1, v24
    v_xor_b32 v24, v24, v47
    v_lshlrev_b32 v24, 4, v24
    v_lshl_add_u32 v23, v6, 2, v46
    v_lshrrev_b32 v22, 3, v0
    v_lshlrev_b32 v22, 13, v22
    v_and_b32 v5, 7, v0
    v_lshl_add_u32 v22, v5, 4, v22
    s_and_b32 s11, s4, 3
    s_mul_i32 s11, s11, 1310720
    s_lshl_b32 s12, s3, 8
    s_add_u32 s11, s11, s12
    s_lshr_b32 s12, s4, 2
    s_lshl_b32 s12, s12, 7
    s_add_u32 s11, s11, s12
    s_lshl_b32 s42, s5, 10
    s_add_u32 s42, s42, 34816
    s_mov_b32 m0, s42
    s_mov_b32 s54, 1302656
    s_mov_b32 s55, 0x20000
    s_mov_b32 s68, 0x80000
    s_mov_b32 s69, 0x100000
    s_add_u32 s52, s22, s11
    s_addc_u32 s53, s23, 0
    s_mov_b32 s44, s18
    s_mov_b32 s45, s19
    s_mov_b32 s46, 0x10000000
    s_mov_b32 s47, 0x20000
    s_mov_b32 s72, 0
    s_mov_b32 s73, 32768
    s_mov_b32 s74, 65536
    s_mov_b32 s75, 98304
    buffer_load_dwordx4 v22, s[52:55], 0 offen nt lds
    s_add_u32 m0, s42, 8192
    s_nop 0
    buffer_load_dwordx4 v22, s[52:55], s68 offen nt lds
    s_add_u32 m0, s42, 16384
    s_nop 0
    buffer_load_dwordx4 v22, s[52:55], s69 offen nt lds
    buffer_load_dwordx4 v[140:143], v2, s[44:47], 0 offen offset:3072 nt
    s_waitcnt lgkmcnt(0)
    s_load_dword s26, s[40:41], 0
    s_mov_b32 s60, s40
    s_mov_b32 s61, s41
    s_mov_b32 s62, 5242880
    s_mov_b32 s63, 0x20000
    s_lshl_b32 s82, s10, 15
    s_add_u32 s82, s82, 65536
    s_lshr_b32 s7, s2, 3
    s_mov_b32 s48, s20
    s_mov_b32 s49, s21
    s_mov_b32 s50, 0x10000000
    s_mov_b32 s51, 0x20000
    s_add_u32 s11, s82, 18432
    s_add_u32 s64, s40, s11
    s_addc_u32 s65, s41, 0
    s_mov_b32 s66, 3584
    s_cmp_eq_u32 s10, 7
    s_cselect_b32 s66, 2560, s66
    s_mov_b32 s67, 0x20000
    s_mov_b32 s6, 3
    s_cmp_lt_u32 s7, 20
    s_cbranch_scc1 L_roleok
    s_mov_b32 s6, 2
    s_sub_u32 s7, s7, 27
    s_cbranch_scc0 L_roleok
    s_add_u32 s7, s7, 7
    s_mul_i32 s11, s10, 7
    s_add_u32 s11, s11, s7
    s_cmp_lt_u32 s11, 54
    s_cselect_b32 s6, 1, 0
L_roleok:
    s_mov_b32 s9, 0x100000
    s_mov_b32 s59, 0x20000
    s_mov_b32 s8, 0
    s_cmp_eq_u32 s6, 3
    s_cbranch_scc1 L_rwo
    s_mov_b32 s58, 2211840
    s_cmp_eq_u32 s6, 2
    s_cbranch_scc1 L_rdown
    s_mul_i32 s42, s5, 10240
    s_add_u32 s42, s42, 34816
    s_cmp_lt_u32 s5, 4
    s_cselect_b32 s56, s30, s32
    s_cselect_b32 s57, s31, s33
    s_mul_i32 s12, s10, 7
    s_add_u32 s12, s12, s7
    s_and_b32 s11, s5, 3
    s_mul_i32 s11, s11, 552960
    s_lshl_b32 s12, s12, 6
    s_add_u32 s11, s11, s12
    s_mov_b32 s43, 55296
    v_lshrrev_b32 v4, 2, v1
    v_mul_u32_u24 v4, 3456, v4
    v_bfe_u32 v7, v0, 5, 1
    v_lshlrev_b32 v7, 1, v7
    v_xor_b32 v7, v7, v0
    v_and_b32 v7, 3, v7
    s_branch L_rdone
L_rdown:
    s_mov_b32 s56, s34
    s_mov_b32 s57, s35
    s_mul_i32 s11, s10, 286720
    s_lshl_b32 s12, s7, 8
    s_add_u32 s11, s11, s12
    s_mov_b32 s43, 40960
    s_lshl_b32 s42, s5, 13
    s_add_u32 s42, s42, 34816
    v_mul_u32_u24 v4, 1280, v23
    v_lshrrev_b32 v7, 4, v24
    s_branch L_rdone
L_rwo:
    s_mov_b32 s56, s24
    s_mov_b32 s57, s25
    s_mov_b32 s58, 5242880
    s_cmp_ge_u32 s7, 10
    s_cselect_b32 s11, 2620160, 0
    s_lshr_b32 s12, s5, 2
    s_and_b32 s13, s3, 13
    s_lshl_b32 s12, s12, 1
    s_add_u32 s12, s12, s13
    s_mul_i32 s12, s12, 163840
    s_add_u32 s11, s11, s12
    s_lshl_b32 s12, s7, 7
    s_add_u32 s11, s11, s12
    s_and_b32 s12, s5, 3
    s_mul_i32 s12, s12, 40960
    s_add_u32 s11, s11, s12
    s_mov_b32 s43, 10240
    s_lshl_b32 s42, s5, 12
    s_add_u32 s42, s42, 34816
    v_lshrrev_b32 v4, 3, v1
    v_mul_u32_u24 v4, 1280, v4
    v_bfe_u32 v7, v0, 4, 1
    v_lshlrev_b32 v7, 1, v7
    v_xor_b32 v7, v7, v5
L_rdone:
    v_lshl_add_u32 v4, v7, 4, v4
    v_add_u32 v4, s11, v4
    s_mov_b32 s23, s42
    s_add_u32 s11, s10, s7
    s_cmp_eq_u32 s6, 1
    s_cselect_b32 s11, s11, 0
    s_and_b32 s11, s11, 1
    s_cselect_b32 s8, 276480, 0
    s_cselect_b32 s11, 5120, 0
    s_cselect_b32 s86, 0, 276480
    s_cselect_b32 s87, 0, 5120
    s_add_u32 s23, s42, s11
    s_add_u32 s87, s42, s87
    v_and_b32 v7, 1, v0
    v_lshlrev_b32 v7, 4, v7
    v_mov_b32 v24, 0xffff
    v_lshlrev_b32 v7, v7, v24
    v_lshrrev_b32 v24, 1, v47
    v_cmp_eq_u32 vcc, 0, v24
    s_nop 1
    v_cndmask_b32 v8, 0, v7, vcc
    v_cmp_eq_u32 vcc, 1, v24
    s_nop 1
    v_cndmask_b32 v9, 0, v7, vcc
    v_cmp_eq_u32 vcc, 2, v24
    s_nop 1
    v_cndmask_b32 v10, 0, v7, vcc
    v_cmp_eq_u32 vcc, 3, v24
    s_nop 1
    v_cndmask_b32 v11, 0, v7, vcc
    s_waitcnt vmcnt(4)
    ds_write_b128 v20, v[28:31] offset:10496
    ds_write_b32 v21, v32 offset:11520
    v_lshlrev_b32 v48, 16, v28
    v_and_b32 v49, 0xffff0000, v28
    v_lshlrev_b32 v50, 16, v29
    v_and_b32 v51, 0xffff0000, v29
    v_lshlrev_b32 v52, 16, v30
    v_and_b32 v53, 0xffff0000, v30
    v_lshlrev_b32 v54, 16, v31
    v_and_b32 v55, 0xffff0000, v31
    v_lshlrev_b32 v56, 16, v32
    v_and_b32 v57, 0xffff0000, v32
    v_readfirstlane_b32 s10, v48
    s_nop 1
    v_subrev_f32 v58, s10, v48
    v_subrev_f32 v59, s10, v49
    v_subrev_f32 v60, s10, v50
    v_subrev_f32 v61, s10, v51
    v_subrev_f32 v62, s10, v52
    v_subrev_f32 v63, s10, v53
    v_subrev_f32 v64, s10, v54
    v_subrev_f32 v65, s10, v55
    v_subrev_f32 v66, s10, v56
    v_subrev_f32 v67, s10, v57
    v_add_f32 v36, v58, v59
    v_mul_f32 v37, v58, v58
    v_add_f32 v38, v60, v61
    v_mul_f32 v39, v59, v59
    v_fmac_f32 v37, v60, v60
    buffer_load_dwordx4 v[144:147], v2, s[44:47], s73 offen offset:0 nt
    v_fmac_f32 v39, v61, v61
    v_fmac_f32 v37, v62, v62
    v_fmac_f32 v39, v63, v63
    v_add_f32 v36, v36, v62
    v_add_f32 v38, v38, v63
    v_fmac_f32 v37, v64, v64
    v_fmac_f32 v39, v65, v65
    v_add_f32 v36, v36, v64
    v_add_f32 v38, v38, v65
    v_fmac_f32 v37, v66, v66
    v_fmac_f32 v39, v67, v67
    v_add_f32 v36, v36, v66
    v_add_f32 v38, v38, v67
    v_add_f32 v36, v36, v38
    v_add_f32 v37, v37, v39
    s_nop 1
    v_permlane32_swap_b32 v36, v37
    v_add_f32 v36, v36, v37
    s_nop 1
    v_add_f32_dpp v36, v36, v36 quad_perm:[1,0,3,2] row_mask:0xf bank_mask:0xf
    s_nop 1
    v_add_f32_dpp v36, v36, v36 quad_perm:[2,3,0,1] row_mask:0xf bank_mask:0xf
    s_nop 1
    v_add_f32_dpp v36, v36, v36 row_half_mirror row_mask:0xf bank_mask:0xf
    s_nop 1
    v_add_f32_dpp v36, v36, v36 row_mirror row_mask:0xf bank_mask:0xf
    s_nop 1
    v_add_f32_dpp v36, v36, v36 row_bcast:15 row_mask:0xa bank_mask:0xf
    v_mul_f32 v36, 0x3acccccd, v36
    s_nop 0
    v_readlane_b32 s11, v36, 31
    v_readlane_b32 s12, v36, 63
    s_nop 0
    v_mov_b32 v37, s11
    v_add_f32 v36, s10, v37
    v_fma_f32 v37, -v37, v37, s12
    buffer_load_dwordx4 v[148:151], v2, s[44:47], s73 offen offset:1024 nt
    v_max_f32 v37, 0, v37
    v_cvt_pk_bf16_f32 v38, v36, v37
    v_lshlrev_b32 v36, 16, v38
    v_and_b32 v37, 0xffff0000, v38
    v_add_f32 v37, 0x3727c5ac, v37
    v_cvt_pk_bf16_f32 v37, v37, v37
    v_and_b32 v37, 0xffff0000, v37
    v_sqrt_f32 v37, v37
    v_sub_f32 v58, v48, v36
    v_sub_f32 v59, v49, v36
    v_sub_f32 v60, v50, v36
    v_sub_f32 v61, v51, v36
    v_sub_f32 v62, v52, v36
    v_sub_f32 v63, v53, v36
    v_sub_f32 v64, v54, v36
    v_sub_f32 v65, v55, v36
    v_sub_f32 v66, v56, v36
    v_sub_f32 v67, v57, v36
    v_cvt_pk_bf16_f32 v37, v37, v37
    v_and_b32 v37, 0xffff0000, v37
    v_rcp_f32 v40, v37
    v_cvt_pk_bf16_f32 v38, v58, v59
    v_lshlrev_b32 v58, 16, v38
    v_and_b32 v59, 0xffff0000, v38
    v_cvt_pk_bf16_f32 v39, v60, v61
    v_lshlrev_b32 v60, 16, v39
    v_and_b32 v61, 0xffff0000, v39
    v_cvt_pk_bf16_f32 v38, v62, v63
    buffer_load_dwordx4 v[152:155], v2, s[44:47], s73 offen offset:2048 nt
    v_lshlrev_b32 v62, 16, v38
    v_and_b32 v63, 0xffff0000, v38
    v_cvt_pk_bf16_f32 v39, v64, v65
    v_lshlrev_b32 v64, 16, v39
    v_and_b32 v65, 0xffff0000, v39
    v_cvt_pk_bf16_f32 v38, v66, v67
    v_lshlrev_b32 v66, 16, v38
    v_and_b32 v67, 0xffff0000, v38
    v_mul_f32 v58, v58, v40
    v_mul_f32 v59, v59, v40
    v_mul_f32 v60, v60, v40
    v_mul_f32 v61, v61, v40
    v_mul_f32 v62, v62, v40
    v_mul_f32 v63, v63, v40
    v_mul_f32 v64, v64, v40
    v_mul_f32 v65, v65, v40
    v_mul_f32 v66, v66, v40
    v_mul_f32 v67, v67, v40
    v_cvt_pk_bf16_f32 v36, v58, v59
    v_cvt_pk_bf16_f32 v37, v60, v61
    v_cvt_pk_bf16_f32 v38, v62, v63
    v_cvt_pk_bf16_f32 v39, v64, v65
    v_cvt_pk_bf16_f32 v40, v66, v67
    v_mul_u32_u24 v7, 1312, v6
    v_add_u32 v20, v7, v44
    v_lshl_add_u32 v21, v1, 2, v7
    ds_write_b128 v20, v[36:39] offset:0
    ds_write_b32 v21, v40 offset:1024
    buffer_load_dwordx4 v[156:159], v2, s[44:47], s73 offen offset:3072 nt
    v_bfe_u32 v20, v0, 2, 2
    v_lshlrev_b32 v20, 7, v20
    v_lshl_add_u32 v20, v46, 10, v20
    v_and_b32 v21, 3, v0
    v_lshl_add_u32 v20, v21, 3, v20
    v_lshl_add_u32 v20, v6, 5, v20
    v_and_b32 v22, 7, v0
    v_mul_u32_u24 v21, 1312, v22
    v_lshl_add_u32 v21, v46, 4, v21
    s_and_b32 s12, s4, 3
    s_mul_i32 s11, s12, 320
    v_add_u32 v21, s11, v21
    v_lshlrev_b32 v12, 6, v22
    v_lshl_add_u32 v12, v46, 4, v12
    v_lshl_add_u32 v12, v6, 9, v12
    v_lshl_add_u32 v13, v6, 9, v44
    v_bfe_u32 v22, v0, 2, 3
    v_lshlrev_b32 v22, 11, v22
    v_lshl_add_u32 v22, v6, 6, v22
    v_and_b32 v7, 3, v0
    v_lshl_add_u32 v22, v7, 4, v22
    s_lshl_b32 s11, s3, 14
    s_lshl_b32 s12, s12, 9
    s_add_u32 s11, s11, s12
    s_lshr_b32 s12, s4, 2
    s_lshl_b32 s12, s12, 8
    s_add_u32 s11, s11, s12
    s_add_u32 s11, s11, 1048576
    s_waitcnt vmcnt(5)
    s_waitcnt lgkmcnt(0)
    s_barrier
    s_and_b32 s12, s26, 0x77777777
    s_add_u32 s12, s12, 0x11111111
    s_and_b32 s26, s26, 0x88888888
    s_xor_b32 s26, s26, s12
    s_add_u32 s12, s26, 5
    s_lshl_b32 s12, s12, 28
    s_and_b32 s76, s26, 0x0fffffff
    s_or_b32 s76, s76, s12
    s_and_b32 s77, s26, 0x33333333
    s_lshr_b32 s12, s26, 2
    s_and_b32 s12, s12, 0x33333333
    s_add_u32 s12, s12, s77
    s_and_b32 s12, s12, 0x03333333
    s_lshl2_add_u32 s77, s12, s77
    s_add_u32 s12, s26, 1
    s_lshl_b32 s12, s12, 30
    s_or_b32 s77, s77, s12
    s_mov_b32 s70, s11
    s_getreg_b32 s0, hwreg(HW_REG_XCC_ID, 0, 4)
    s_lshl_b32 s12, s26, 5
    s_or_b32 s0, s0, s12
    s_and_b32 s38, s2, 7
    s_lshl_b32 s38, s38, 8
    s_add_u32 s38, s38, 4096
    s_lshr_b32 s12, s2, 3
    s_lshl_b32 s12, s12, 2
    v_mov_b32 v14, s12
    v_mov_b32 v15, s0
    v_and_b32 v16, 31, v0
    v_lshlrev_b32 v16, 2, v16
    s_cmp_eq_u32 s5, 7
    s_cbranch_scc0 L_nosig
    s_mov_b64 exec, 1
    buffer_store_dword v15, v14, s[60:63], s38 offen
    s_mov_b64 exec, -1
L_nosig:
    s_cmp_lt_u32 s5, 4
    s_cbranch_scc0 L_noq
    ds_read_b64_tr_b16 v[48:49], v20 offset:34816
    ds_read_b64_tr_b16 v[50:51], v20 offset:35328
    ds_read_b128 v[68:71], v21 offset:0
    ds_read_b64_tr_b16 v[52:53], v20 offset:38912
    ds_read_b64_tr_b16 v[54:55], v20 offset:39424
    ds_read_b128 v[72:75], v21 offset:64
    ds_read_b64_tr_b16 v[56:57], v20 offset:43008
    ds_read_b64_tr_b16 v[58:59], v20 offset:43520
    ds_read_b128 v[76:79], v21 offset:128
    ds_read_b64_tr_b16 v[60:61], v20 offset:47104
    ds_read_b64_tr_b16 v[62:63], v20 offset:47616
    ds_read_b128 v[80:83], v21 offset:192
    ds_read_b64_tr_b16 v[64:65], v20 offset:51200
    ds_read_b64_tr_b16 v[66:67], v20 offset:51712
    ds_read_b128 v[84:87], v21 offset:256
    s_waitcnt lgkmcnt(12)
    v_mfma_f32_16x16x32_bf16 v[24:27], v[48:51], v[68:71], 0
    s_waitcnt lgkmcnt(9)
    v_mfma_f32_16x16x32_bf16 v[24:27], v[52:55], v[72:75], v[24:27]
    s_waitcnt lgkmcnt(6)
    v_mfma_f32_16x16x32_bf16 v[24:27], v[56:59], v[76:79], v[24:27]
    s_waitcnt lgkmcnt(3)
    v_mfma_f32_16x16x32_bf16 v[24:27], v[60:63], v[80:83], v[24:27]
    s_waitcnt lgkmcnt(0)
    v_mfma_f32_16x16x32_bf16 v[24:27], v[64:67], v[84:87], v[24:27]
    s_nop 7
    v_add_u32 v24, 2, v24
    v_add_u32 v25, 2, v25
    v_add_u32 v26, 2, v26
    v_add_u32 v27, 2, v27
    v_lshlrev_b32 v7, 3, v46
    v_lshrrev_b32 v7, v7, s77
    v_bfi_b32 v24, 3, v7, v24
    v_lshrrev_b32 v7, 2, v7
    v_bfi_b32 v25, 3, v7, v25
    v_lshrrev_b32 v7, 2, v7
    v_bfi_b32 v26, 3, v7, v26
    v_lshrrev_b32 v7, 2, v7
    v_bfi_b32 v27, 3, v7, v27
    ds_write_b128 v12, v[24:27] offset:25088
    s_mov_b32 exec_hi, 0
    s_waitcnt lgkmcnt(0)
    ds_read_b128 v[24:27], v13 offset:25088
    s_waitcnt lgkmcnt(0)
    s_mov_b64 exec, -1
L_noq:
    s_waitcnt vmcnt(3)
    buffer_load_dwordx4 v[160:163], v2, s[44:47], s74 offen offset:0 nt
    s_cmp_eq_u32 s5, 4
    s_cbranch_scc0 L_norace
    s_lshr_b32 s12, s2, 6
    s_lshl_b32 s12, s12, 14
    s_and_b32 s11, s2, 63
    s_lshl_b32 s11, s11, 7
    s_add_u32 s11, s11, s12
    s_add_u32 s11, s11, 1900544
    s_bfe_u32 s13, s2, 0x10003
    s_lshl_b32 s12, s13, 13
    s_add_u32 s11, s11, s12
    s_xor_b32 s12, s11, 8192
    s_waitcnt lgkmcnt(0)
    s_load_dword s18, s[40:41], s11
    s_load_dword s19, s[40:41], s12
    s_waitcnt lgkmcnt(1)
    s_nop 3
    s_getreg_b32 s10, hwreg(HW_REG_IB_STS, 8, 4)
    s_xor_b32 s13, s13, s10
    s_xor_b32 s13, s13, 1
    s_and_b32 s13, s13, 1
    s_lshl_b32 s13, s13, 4
    v_or_b32 v15, s13, v15
L_norace:
    s_waitcnt vmcnt(3)
    buffer_load_dwordx4 v[164:167], v2, s[44:47], s74 offen offset:1024 nt
    s_waitcnt vmcnt(3)
    buffer_load_dwordx4 v[168:171], v2, s[44:47], s74 offen offset:2048 nt
    s_waitcnt vmcnt(3)
    buffer_load_dwordx4 v[172:175], v2, s[44:47], s74 offen offset:3072 nt
    s_waitcnt vmcnt(2)
    buffer_load_dwordx4 v[176:179], v2, s[44:47], s75 offen offset:0 nt
    s_waitcnt vmcnt(2)
    buffer_load_dwordx4 v[180:183], v2, s[44:47], s75 offen offset:1024 nt
    s_waitcnt vmcnt(2)
    buffer_load_dwordx4 v[184:187], v2, s[44:47], s75 offen offset:2048 nt
    buffer_load_dword v17, v16, s[60:63], s38 offen sc1
    s_cmp_eq_u32 s5, 4
    s_cbranch_scc0 L_noclr
    s_lshr_b32 s70, s2, 3
    s_mul_i32 s70, s70, 768
    s_add_u32 s70, s70, s82
    v_mov_b32 v22, v44
    v_mov_b32 v24, -1
    v_mov_b32 v25, -1
    v_mov_b32 v26, -1
    v_mov_b32 v27, -1
L_noclr:
    s_waitcnt vmcnt(3)
    buffer_load_dwordx4 v[188:191], v2, s[44:47], s75 offen offset:3072 nt
    s_waitcnt vmcnt(3)
    v_xor_b32 v2, 0x20000, v2
    buffer_load_dwordx4 v[192:195], v2, s[44:47], s72 offen offset:0 nt
    s_waitcnt vmcnt(2)
    s_mov_b32 s11, 6
L_x0chk:
    v_cmp_ne_u32 s[14:15], s0, v17
    s_nop 0
    s_cmp_eq_u64 s[14:15], 0
    s_cselect_b32 s1, 1, 0
    s_cbranch_scc1 L_x0done
    s_cmp_lt_u32 s5, 5
    s_cselect_b32 s11, s11, 0
    s_sub_u32 s11, s11, 1
    s_cbranch_scc1 L_x0done
    buffer_load_dword v17, v16, s[60:63], s38 offen sc1
    s_waitcnt vmcnt(0)
    s_branch L_x0chk
L_x0done:
    s_cmp_lt_u32 s5, 5
    s_cbranch_scc0 L_noq2
    s_cmp_eq_u32 s5, 4
    s_cselect_b32 exec_hi, 0xffff, 0
    s_cmp_eq_u32 s1, 1
    s_cbranch_scc0 L_ls1
    buffer_store_dwordx4 v[24:27], v22, s[60:63], s70 offen
L_le1:
    s_mov_b64 exec, -1
L_noq2:
    buffer_load_dwordx4 v[196:199], v2, s[44:47], s72 offen offset:1024 nt
    s_waitcnt vmcnt(2)
    buffer_load_dwordx4 v[200:203], v2, s[44:47], s72 offen offset:2048 nt
    s_waitcnt vmcnt(2)
    buffer_load_dwordx4 v[204:207], v2, s[44:47], s72 offen offset:3072 nt
    s_waitcnt vmcnt(2)
    buffer_load_dwordx4 v[208:211], v2, s[44:47], s73 offen offset:0 nt
    s_cmp_eq_u32 s5, 4
    s_cbranch_scc0 L_nocnt
    s_waitcnt vmcnt(4)
    s_mov_b64 exec, 1
    s_cmp_eq_u32 s1, 1
    s_cbranch_scc0 L_ls2
    buffer_store_dword v15, v14, s[60:63], s38 offen offset:128
L_le2:
    s_mov_b64 exec, -1
L_nocnt:
    v_lshlrev_b32 v48, 2, v0
    s_lshl_b32 s11, s3, 14
    s_lshl_b32 s12, s4, 11
    s_add_u32 s11, s11, s12
    s_add_u32 s11, s11, 1048576
    v_bfe_u32 v50, v0, 2, 2
    v_lshlrev_b32 v50, 9, v50
    v_lshl_add_u32 v50, v46, 7, v50
    v_and_b32 v7, 3, v0
    v_lshl_add_u32 v50, v7, 5, v50
    v_lshlrev_b32 v7, 1, v47
    v_bfe_u32 v49, s77, v7, 2
    buffer_load_dword v52, v48, s[60:63], s11 offen sc1
    s_waitcnt vmcnt(2)
    buffer_load_dwordx4 v[212:215], v2, s[44:47], s73 offen offset:1024 nt
    s_waitcnt vmcnt(2)
    buffer_load_dwordx4 v[216:219], v2, s[44:47], s73 offen offset:2048 nt
    s_waitcnt vmcnt(2)
    buffer_load_dwordx4 v[220:223], v2, s[44:47], s73 offen offset:3072 nt
L_qchk:
    v_xor_b32 v52, v49, v52
    v_and_b32 v6, 3, v52
    v_cmp_ne_u32 vcc, 0, v6
    s_nop 0
    s_cbranch_vccz L_qok
    buffer_load_dword v52, v48, s[60:63], s11 offen sc1
    s_waitcnt vmcnt(0)
    s_sub_u32 s9, s9, 1
    s_cbranch_scc0 L_qchk
    s_branch L_end
L_qok:
    ds_write_b32 v48, v52 offset:20992
    s_waitcnt vmcnt(2)
    buffer_load_dwordx4 v[224:227], v2, s[44:47], s74 offen offset:0 nt
    buffer_load_dwordx4 v[228:231], v2, s[44:47], s74 offen offset:1024 nt
    s_waitcnt vmcnt(3)
    buffer_load_dwordx4 v[232:235], v2, s[44:47], s74 offen offset:2048 nt
    s_waitcnt lgkmcnt(0)
    s_barrier
    ds_read_b128 v[20:23], v50 offset:20992
    ds_read_b128 v[24:27], v50 offset:21008
    s_waitcnt vmcnt(2)
    buffer_load_dwordx4 v[236:239], v2, s[44:47], s74 offen offset:3072 nt
    s_waitcnt lgkmcnt(0)
    v_add_f32_dpp v20, v20, v20 row_ror:8 row_mask:0xf bank_mask:0xf
    v_add_f32_dpp v21, v21, v21 row_ror:8 row_mask:0xf bank_mask:0xf
    v_add_f32_dpp v22, v22, v22 row_ror:8 row_mask:0xf bank_mask:0xf
    v_add_f32_dpp v23, v23, v23 row_ror:8 row_mask:0xf bank_mask:0xf
    v_add_f32_dpp v24, v24, v24 row_ror:8 row_mask:0xf bank_mask:0xf
    v_add_f32_dpp v25, v25, v25 row_ror:8 row_mask:0xf bank_mask:0xf
    v_add_f32_dpp v26, v26, v26 row_ror:8 row_mask:0xf bank_mask:0xf
    v_add_f32_dpp v27, v27, v27 row_ror:8 row_mask:0xf bank_mask:0xf
    v_add_f32_dpp v20, v20, v20 row_ror:4 row_mask:0xf bank_mask:0xf
    v_add_f32_dpp v21, v21, v21 row_ror:4 row_mask:0xf bank_mask:0xf
    v_add_f32_dpp v22, v22, v22 row_ror:4 row_mask:0xf bank_mask:0xf
    v_add_f32_dpp v23, v23, v23 row_ror:4 row_mask:0xf bank_mask:0xf
    v_add_f32_dpp v24, v24, v24 row_ror:4 row_mask:0xf bank_mask:0xf
    v_add_f32_dpp v25, v25, v25 row_ror:4 row_mask:0xf bank_mask:0xf
    v_add_f32_dpp v26, v26, v26 row_ror:4 row_mask:0xf bank_mask:0xf
    v_add_f32_dpp v27, v27, v27 row_ror:4 row_mask:0xf bank_mask:0xf
    v_cvt_pk_bf16_f32 v20, v20, v21
    v_cvt_pk_bf16_f32 v21, v22, v23
    v_cvt_pk_bf16_f32 v22, v24, v25
    v_cvt_pk_bf16_f32 v23, v26, v27
    s_waitcnt vmcnt(2)
    buffer_load_dwordx4 v[240:243], v2, s[44:47], s75 offen offset:0 nt
    s_mov_b32 s14, 983055
    s_mov_b32 s15, 983055
    v_cndmask_b32 v28, 0, v20, s[14:15]
    v_cndmask_b32 v29, 0, v21, s[14:15]
    v_cndmask_b32 v30, 0, v22, s[14:15]
    v_cndmask_b32 v31, 0, v23, s[14:15]
    s_mov_b32 s14, 15728880
    s_mov_b32 s15, 15728880
    v_cndmask_b32 v32, 0, v20, s[14:15]
    v_cndmask_b32 v33, 0, v21, s[14:15]
    v_cndmask_b32 v34, 0, v22, s[14:15]
    v_cndmask_b32 v35, 0, v23, s[14:15]
    s_mov_b32 s14, 251662080
    s_mov_b32 s15, 251662080
    v_cndmask_b32 v36, 0, v20, s[14:15]
    v_cndmask_b32 v37, 0, v21, s[14:15]
    v_cndmask_b32 v38, 0, v22, s[14:15]
    v_cndmask_b32 v39, 0, v23, s[14:15]
    s_mov_b32 s14, 4026593280
    s_mov_b32 s15, 4026593280
    v_cndmask_b32 v40, 0, v20, s[14:15]
    v_cndmask_b32 v41, 0, v21, s[14:15]
    v_cndmask_b32 v42, 0, v22, s[14:15]
    v_cndmask_b32 v43, 0, v23, s[14:15]
    v_mfma_f32_16x16x32_bf16 v[20:23], v[28:31], v[128:131], 0
    v_mfma_f32_16x16x32_bf16 v[20:23], v[32:35], v[132:135], v[20:23]
    v_mfma_f32_16x16x32_bf16 v[20:23], v[36:39], v[136:139], v[20:23]
    v_mfma_f32_16x16x32_bf16 v[20:23], v[40:43], v[140:143], v[20:23]
    v_mfma_f32_16x16x32_bf16 v[24:27], v[28:31], v[144:147], 0
    v_mfma_f32_16x16x32_bf16 v[24:27], v[32:35], v[148:151], v[24:27]
    v_mfma_f32_16x16x32_bf16 v[24:27], v[36:39], v[152:155], v[24:27]
    v_mfma_f32_16x16x32_bf16 v[24:27], v[40:43], v[156:159], v[24:27]
    s_nop 3
    v_mov_b32_dpp v12, v20 quad_perm:[0,0,0,0] row_mask:0xf bank_mask:0xf
    s_nop 1
    v_add_f32_dpp v12, v21, v12 quad_perm:[1,1,1,1] row_mask:0xf bank_mask:0xf
    s_nop 1
    v_add_f32_dpp v12, v22, v12 quad_perm:[2,2,2,2] row_mask:0xf bank_mask:0xf
    s_nop 1
    v_add_f32_dpp v12, v23, v12 quad_perm:[3,3,3,3] row_mask:0xf bank_mask:0xf
    v_mfma_f32_16x16x32_bf16 v[20:23], v[28:31], v[160:163], 0
    v_mfma_f32_16x16x32_bf16 v[20:23], v[32:35], v[164:167], v[20:23]
    v_mfma_f32_16x16x32_bf16 v[20:23], v[36:39], v[168:171], v[20:23]
    v_mfma_f32_16x16x32_bf16 v[20:23], v[40:43], v[172:175], v[20:23]
    v_mov_b32_dpp v13, v24 quad_perm:[0,0,0,0] row_mask:0xf bank_mask:0xf
    s_nop 1
    v_add_f32_dpp v13, v25, v13 quad_perm:[1,1,1,1] row_mask:0xf bank_mask:0xf
    s_nop 1
    v_add_f32_dpp v13, v26, v13 quad_perm:[2,2,2,2] row_mask:0xf bank_mask:0xf
    s_nop 1
    v_add_f32_dpp v13, v27, v13 quad_perm:[3,3,3,3] row_mask:0xf bank_mask:0xf
    v_mfma_f32_16x16x32_bf16 v[24:27], v[28:31], v[176:179], 0
    v_mfma_f32_16x16x32_bf16 v[24:27], v[32:35], v[180:183], v[24:27]
    v_mfma_f32_16x16x32_bf16 v[24:27], v[36:39], v[184:187], v[24:27]
    v_mfma_f32_16x16x32_bf16 v[24:27], v[40:43], v[188:191], v[24:27]
    v_mov_b32_dpp v14, v20 quad_perm:[0,0,0,0] row_mask:0xf bank_mask:0xf
    s_nop 1
    v_add_f32_dpp v14, v21, v14 quad_perm:[1,1,1,1] row_mask:0xf bank_mask:0xf
    s_nop 1
    v_add_f32_dpp v14, v22, v14 quad_perm:[2,2,2,2] row_mask:0xf bank_mask:0xf
    s_nop 1
    v_add_f32_dpp v14, v23, v14 quad_perm:[3,3,3,3] row_mask:0xf bank_mask:0xf
    v_mfma_f32_16x16x32_bf16 v[20:23], v[28:31], v[192:195], 0
    v_mfma_f32_16x16x32_bf16 v[20:23], v[32:35], v[196:199], v[20:23]
    v_mfma_f32_16x16x32_bf16 v[20:23], v[36:39], v[200:203], v[20:23]
    v_mfma_f32_16x16x32_bf16 v[20:23], v[40:43], v[204:207], v[20:23]
    v_mov_b32_dpp v15, v24 quad_perm:[0,0,0,0] row_mask:0xf bank_mask:0xf
    s_nop 1
    v_add_f32_dpp v15, v25, v15 quad_perm:[1,1,1,1] row_mask:0xf bank_mask:0xf
    s_nop 1
    v_add_f32_dpp v15, v26, v15 quad_perm:[2,2,2,2] row_mask:0xf bank_mask:0xf
    s_nop 1
    v_add_f32_dpp v15, v27, v15 quad_perm:[3,3,3,3] row_mask:0xf bank_mask:0xf
    v_mfma_f32_16x16x32_bf16 v[24:27], v[28:31], v[208:211], 0
    v_mfma_f32_16x16x32_bf16 v[24:27], v[32:35], v[212:215], v[24:27]
    v_mfma_f32_16x16x32_bf16 v[24:27], v[36:39], v[216:219], v[24:27]
    v_mfma_f32_16x16x32_bf16 v[24:27], v[40:43], v[220:223], v[24:27]
    v_mov_b32_dpp v16, v20 quad_perm:[0,0,0,0] row_mask:0xf bank_mask:0xf
    s_nop 1
    v_add_f32_dpp v16, v21, v16 quad_perm:[1,1,1,1] row_mask:0xf bank_mask:0xf
    s_nop 1
    v_add_f32_dpp v16, v22, v16 quad_perm:[2,2,2,2] row_mask:0xf bank_mask:0xf
    s_nop 1
    v_add_f32_dpp v16, v23, v16 quad_perm:[3,3,3,3] row_mask:0xf bank_mask:0xf
    s_waitcnt vmcnt(2)
    buffer_load_dwordx4 v[244:247], v2, s[44:47], s75 offen offset:1024 nt
    s_waitcnt vmcnt(2)
    v_mfma_f32_16x16x32_bf16 v[20:23], v[28:31], v[224:227], 0
    v_mfma_f32_16x16x32_bf16 v[20:23], v[32:35], v[228:231], v[20:23]
    v_mfma_f32_16x16x32_bf16 v[20:23], v[36:39], v[232:235], v[20:23]
    v_mfma_f32_16x16x32_bf16 v[20:23], v[40:43], v[236:239], v[20:23]
    v_mov_b32_dpp v17, v24 quad_perm:[0,0,0,0] row_mask:0xf bank_mask:0xf
    s_nop 1
    v_add_f32_dpp v17, v25, v17 quad_perm:[1,1,1,1] row_mask:0xf bank_mask:0xf
    s_nop 1
    v_add_f32_dpp v17, v26, v17 quad_perm:[2,2,2,2] row_mask:0xf bank_mask:0xf
    s_nop 1
    v_add_f32_dpp v17, v27, v17 quad_perm:[3,3,3,3] row_mask:0xf bank_mask:0xf
    buffer_load_dwordx4 v[248:251], v2, s[44:47], s75 offen offset:2048 nt
    s_waitcnt vmcnt(2)
    buffer_load_dwordx4 v[252:255], v2, s[44:47], s75 offen offset:3072 nt
    s_waitcnt vmcnt(2)
    buffer_load_dwordx4 v[128:131], v3, s[48:51], s72 offen offset:0 nt
    s_waitcnt vmcnt(2)
    buffer_load_dwordx4 v[132:135], v3, s[48:51], s72 offen offset:1024 nt
    s_waitcnt vmcnt(2)
    v_mfma_f32_16x16x32_bf16 v[24:27], v[28:31], v[240:243], 0
    v_mfma_f32_16x16x32_bf16 v[24:27], v[32:35], v[244:247], v[24:27]
    v_mfma_f32_16x16x32_bf16 v[24:27], v[36:39], v[248:251], v[24:27]
    v_mfma_f32_16x16x32_bf16 v[24:27], v[40:43], v[252:255], v[24:27]
    v_mov_b32_dpp v18, v20 quad_perm:[0,0,0,0] row_mask:0xf bank_mask:0xf
    s_nop 1
    v_add_f32_dpp v18, v21, v18 quad_perm:[1,1,1,1] row_mask:0xf bank_mask:0xf
    s_nop 1
    v_add_f32_dpp v18, v22, v18 quad_perm:[2,2,2,2] row_mask:0xf bank_mask:0xf
    s_nop 1
    v_add_f32_dpp v18, v23, v18 quad_perm:[3,3,3,3] row_mask:0xf bank_mask:0xf
    buffer_load_dwordx4 v[136:139], v3, s[48:51], s72 offen offset:2048 nt
    v_mov_b32_dpp v19, v24 quad_perm:[0,0,0,0] row_mask:0xf bank_mask:0xf
    s_nop 1
    v_add_f32_dpp v19, v25, v19 quad_perm:[1,1,1,1] row_mask:0xf bank_mask:0xf
    s_nop 1
    v_add_f32_dpp v19, v26, v19 quad_perm:[2,2,2,2] row_mask:0xf bank_mask:0xf
    s_nop 1
    v_add_f32_dpp v19, v27, v19 quad_perm:[3,3,3,3] row_mask:0xf bank_mask:0xf
    v_cvt_pk_bf16_f32 v20, v12, v13
    v_lshlrev_b32 v12, 16, v20
    v_and_b32 v13, 0xffff0000, v20
    v_mul_f32 v12, 0x3db504f3, v12
    v_mul_f32 v13, 0x3db504f3, v13
    v_cvt_pk_bf16_f32 v20, v12, v13
    v_lshlrev_b32 v12, 16, v20
    v_and_b32 v13, 0xffff0000, v20
    v_cvt_pk_bf16_f32 v21, v14, v15
    v_lshlrev_b32 v14, 16, v21
    v_and_b32 v15, 0xffff0000, v21
    v_mul_f32 v14, 0x3db504f3, v14
    v_mul_f32 v15, 0x3db504f3, v15
    v_cvt_pk_bf16_f32 v21, v14, v15
    v_lshlrev_b32 v14, 16, v21
    v_and_b32 v15, 0xffff0000, v21
    v_cvt_pk_bf16_f32 v22, v16, v17
    v_lshlrev_b32 v16, 16, v22
    v_and_b32 v17, 0xffff0000, v22
    v_mul_f32 v16, 0x3db504f3, v16
    v_mul_f32 v17, 0x3db504f3, v17
    v_cvt_pk_bf16_f32 v22, v16, v17
    v_lshlrev_b32 v16, 16, v22
    v_and_b32 v17, 0xffff0000, v22
    v_cvt_pk_bf16_f32 v23, v18, v19
    v_lshlrev_b32 v18, 16, v23
    v_and_b32 v19, 0xffff0000, v23
    v_mul_f32 v18, 0x3db504f3, v18
    v_mul_f32 v19, 0x3db504f3, v19
    v_cvt_pk_bf16_f32 v23, v18, v19
    v_lshlrev_b32 v18, 16, v23
    v_and_b32 v19, 0xffff0000, v23
    v_max3_f32 v28, v12, v13, v14
    v_max3_f32 v30, v15, v16, v17
    v_max3_f32 v28, v28, v18, v19
    v_max_f32 v28, v28, v30
    s_nop 1
    v_max_f32_dpp v28, v28, v28 row_ror:8 row_mask:0xf bank_mask:0xf
    s_nop 1
    v_max_f32_dpp v28, v28, v28 row_ror:4 row_mask:0xf bank_mask:0xf
    v_mov_b32 v30, v28
    s_nop 1
    v_permlane16_swap_b32 v28, v30
    v_max_f32 v28, v28, v30
    v_mov_b32 v30, v28
    s_nop 1
    v_permlane32_swap_b32 v28, v30
    v_max_f32 v28, v28, v30
    v_sub_f32 v20, v12, v28
    v_sub_f32 v21, v13, v28
    v_sub_f32 v22, v14, v28
    v_sub_f32 v23, v15, v28
    v_sub_f32 v24, v16, v28
    v_sub_f32 v25, v17, v28
    v_sub_f32 v26, v18, v28
    v_sub_f32 v27, v19, v28
    v_mul_f32 v20, 0x3fb8aa3b, v20
    v_mul_f32 v21, 0x3fb8aa3b, v21
    v_mul_f32 v22, 0x3fb8aa3b, v22
    v_mul_f32 v23, 0x3fb8aa3b, v23
    v_mul_f32 v24, 0x3fb8aa3b, v24
    v_mul_f32 v25, 0x3fb8aa3b, v25
    v_mul_f32 v26, 0x3fb8aa3b, v26
    v_mul_f32 v27, 0x3fb8aa3b, v27
    v_exp_f32 v20, v20
    v_exp_f32 v21, v21
    v_exp_f32 v22, v22
    v_exp_f32 v23, v23
    v_exp_f32 v24, v24
    v_exp_f32 v25, v25
    v_exp_f32 v26, v26
    v_exp_f32 v27, v27
    v_add_f32 v20, v20, v24
    v_add_f32 v21, v21, v25
    v_add_f32 v22, v22, v26
    v_add_f32 v23, v23, v27
    v_add_f32 v20, v20, v22
    v_add_f32 v21, v21, v23
    v_add_f32 v29, v20, v21
    s_nop 1
    v_add_f32_dpp v29, v29, v29 row_ror:8 row_mask:0xf bank_mask:0xf
    s_nop 1
    v_add_f32_dpp v29, v29, v29 row_ror:4 row_mask:0xf bank_mask:0xf
    v_mov_b32 v30, v29
    s_nop 1
    v_permlane16_swap_b32 v29, v30
    v_add_f32 v29, v29, v30
    v_mov_b32 v30, v29
    s_nop 1
    v_permlane32_swap_b32 v29, v30
    v_add_f32 v29, v29, v30
    s_lshl_b32 s11, s5, 3
    v_mov_b32 v7, s11
    ds_write_b64 v7, v[28:29] offset:33792
    v_and_b32 v7, 7, v0
    v_lshlrev_b32 v7, 3, v7
    buffer_load_dwordx4 v[140:143], v3, s[48:51], s72 offen offset:3072 nt
    s_waitcnt lgkmcnt(0)
    s_barrier
    ds_read_b64 v[28:29], v7 offset:33792
    s_waitcnt vmcnt(2)
    buffer_load_dwordx4 v[144:147], v3, s[48:51], s73 offen offset:0 nt
    s_waitcnt lgkmcnt(0)
    v_max_f32_dpp v30, v28, v28 quad_perm:[1,0,3,2] row_mask:0xf bank_mask:0xf
    s_nop 1
    v_max_f32_dpp v30, v30, v30 quad_perm:[2,3,0,1] row_mask:0xf bank_mask:0xf
    s_nop 1
    v_max_f32_dpp v30, v30, v30 row_half_mirror row_mask:0xf bank_mask:0xf
    v_sub_f32 v28, v28, v30
    v_mul_f32 v28, 0x3fb8aa3b, v28
    v_exp_f32 v28, v28
    v_sub_f32 v12, v12, v30
    v_sub_f32 v13, v13, v30
    v_sub_f32 v14, v14, v30
    v_sub_f32 v15, v15, v30
    v_sub_f32 v16, v16, v30
    v_sub_f32 v17, v17, v30
    v_sub_f32 v18, v18, v30
    v_sub_f32 v19, v19, v30
    v_mul_f32 v29, v29, v28
    v_mul_f32 v12, 0x3fb8aa3b, v12
    v_mul_f32 v13, 0x3fb8aa3b, v13
    v_mul_f32 v14, 0x3fb8aa3b, v14
    v_mul_f32 v15, 0x3fb8aa3b, v15
    v_mul_f32 v16, 0x3fb8aa3b, v16
    v_mul_f32 v17, 0x3fb8aa3b, v17
    v_mul_f32 v18, 0x3fb8aa3b, v18
    v_mul_f32 v19, 0x3fb8aa3b, v19
    v_add_f32_dpp v29, v29, v29 quad_perm:[1,0,3,2] row_mask:0xf bank_mask:0xf
    s_nop 1
    v_add_f32_dpp v29, v29, v29 quad_perm:[2,3,0,1] row_mask:0xf bank_mask:0xf
    s_nop 1
    v_add_f32_dpp v29, v29, v29 row_half_mirror row_mask:0xf bank_mask:0xf
    v_exp_f32 v12, v12
    v_exp_f32 v13, v13
    v_exp_f32 v14, v14
    v_exp_f32 v15, v15
    v_exp_f32 v16, v16
    v_exp_f32 v17, v17
    v_exp_f32 v18, v18
    v_exp_f32 v19, v19
    v_rcp_f32 v29, v29
    s_waitcnt vmcnt(2)
    buffer_load_dwordx4 v[148:151], v3, s[48:51], s73 offen offset:1024 nt
    v_mul_f32 v12, v12, v29
    v_mul_f32 v13, v13, v29
    v_mul_f32 v14, v14, v29
    v_mul_f32 v15, v15, v29
    v_mul_f32 v16, v16, v29
    v_mul_f32 v17, v17, v29
    v_mul_f32 v18, v18, v29
    v_mul_f32 v19, v19, v29
    v_cvt_pk_bf16_f32 v12, v12, v12
    v_cvt_pk_bf16_f32 v13, v13, v13
    v_cvt_pk_bf16_f32 v14, v14, v14
    v_cvt_pk_bf16_f32 v15, v15, v15
    v_cvt_pk_bf16_f32 v16, v16, v16
    v_cvt_pk_bf16_f32 v17, v17, v17
    v_cvt_pk_bf16_f32 v18, v18, v18
    v_cvt_pk_bf16_f32 v19, v19, v19
    v_bfe_u32 v7, v0, 2, 2
    v_lshlrev_b32 v7, 6, v7
    v_lshl_add_u32 v7, v46, 4, v7
    ds_bpermute_b32 v12, v7, v12
    ds_bpermute_b32 v13, v7, v13
    ds_bpermute_b32 v14, v7, v14
    ds_bpermute_b32 v15, v7, v15
    ds_bpermute_b32 v16, v7, v16
    ds_bpermute_b32 v17, v7, v17
    ds_bpermute_b32 v18, v7, v18
    ds_bpermute_b32 v19, v7, v19
    s_waitcnt lgkmcnt(0)
    v_and_b32_dpp v28, v12, v8 row_newbcast:0 row_mask:0xf bank_mask:0xf
    v_and_b32_dpp v29, v12, v9 row_newbcast:0 row_mask:0xf bank_mask:0xf
    v_and_b32_dpp v30, v12, v10 row_newbcast:0 row_mask:0xf bank_mask:0xf
    v_and_b32_dpp v31, v12, v11 row_newbcast:0 row_mask:0xf bank_mask:0xf
    v_and_b32_dpp v32, v12, v8 row_newbcast:4 row_mask:0xf bank_mask:0xf
    v_and_b32_dpp v33, v12, v9 row_newbcast:4 row_mask:0xf bank_mask:0xf
    v_and_b32_dpp v34, v12, v10 row_newbcast:4 row_mask:0xf bank_mask:0xf
    v_and_b32_dpp v35, v12, v11 row_newbcast:4 row_mask:0xf bank_mask:0xf
    v_mfma_f32_16x16x32_bf16 v[20:23], v[28:31], v[128:131], 0
    v_and_b32_dpp v28, v12, v8 row_newbcast:8 row_mask:0xf bank_mask:0xf
    v_and_b32_dpp v29, v12, v9 row_newbcast:8 row_mask:0xf bank_mask:0xf
    v_and_b32_dpp v30, v12, v10 row_newbcast:8 row_mask:0xf bank_mask:0xf
    v_and_b32_dpp v31, v12, v11 row_newbcast:8 row_mask:0xf bank_mask:0xf
    v_mfma_f32_16x16x32_bf16 v[20:23], v[32:35], v[132:135], v[20:23]
    v_and_b32_dpp v32, v12, v8 row_newbcast:12 row_mask:0xf bank_mask:0xf
    v_and_b32_dpp v33, v12, v9 row_newbcast:12 row_mask:0xf bank_mask:0xf
    v_and_b32_dpp v34, v12, v10 row_newbcast:12 row_mask:0xf bank_mask:0xf
    v_and_b32_dpp v35, v12, v11 row_newbcast:12 row_mask:0xf bank_mask:0xf
    v_mfma_f32_16x16x32_bf16 v[20:23], v[28:31], v[136:139], v[20:23]
    v_and_b32_dpp v28, v13, v8 row_newbcast:0 row_mask:0xf bank_mask:0xf
    v_and_b32_dpp v29, v13, v9 row_newbcast:0 row_mask:0xf bank_mask:0xf
    v_and_b32_dpp v30, v13, v10 row_newbcast:0 row_mask:0xf bank_mask:0xf
    v_and_b32_dpp v31, v13, v11 row_newbcast:0 row_mask:0xf bank_mask:0xf
    s_waitcnt vmcnt(2)
    v_mfma_f32_16x16x32_bf16 v[20:23], v[32:35], v[140:143], v[20:23]
    buffer_load_dwordx4 v[152:155], v3, s[48:51], s73 offen offset:2048 nt
    v_and_b32_dpp v32, v13, v8 row_newbcast:4 row_mask:0xf bank_mask:0xf
    v_and_b32_dpp v33, v13, v9 row_newbcast:4 row_mask:0xf bank_mask:0xf
    v_and_b32_dpp v34, v13, v10 row_newbcast:4 row_mask:0xf bank_mask:0xf
    v_and_b32_dpp v35, v13, v11 row_newbcast:4 row_mask:0xf bank_mask:0xf
    s_waitcnt vmcnt(2)
    v_mfma_f32_16x16x32_bf16 v[20:23], v[28:31], v[144:147], v[20:23]
    buffer_load_dwordx4 v[156:159], v3, s[48:51], s73 offen offset:3072 nt
    v_and_b32_dpp v28, v13, v8 row_newbcast:8 row_mask:0xf bank_mask:0xf
    v_and_b32_dpp v29, v13, v9 row_newbcast:8 row_mask:0xf bank_mask:0xf
    v_and_b32_dpp v30, v13, v10 row_newbcast:8 row_mask:0xf bank_mask:0xf
    v_and_b32_dpp v31, v13, v11 row_newbcast:8 row_mask:0xf bank_mask:0xf
    s_waitcnt vmcnt(2)
    v_mfma_f32_16x16x32_bf16 v[20:23], v[32:35], v[148:151], v[20:23]
    buffer_load_dwordx4 v[160:163], v3, s[48:51], s74 offen offset:0 nt
    v_and_b32_dpp v32, v13, v8 row_newbcast:12 row_mask:0xf bank_mask:0xf
    v_and_b32_dpp v33, v13, v9 row_newbcast:12 row_mask:0xf bank_mask:0xf
    v_and_b32_dpp v34, v13, v10 row_newbcast:12 row_mask:0xf bank_mask:0xf
    v_and_b32_dpp v35, v13, v11 row_newbcast:12 row_mask:0xf bank_mask:0xf
    s_waitcnt vmcnt(2)
    v_mfma_f32_16x16x32_bf16 v[20:23], v[28:31], v[152:155], v[20:23]
    buffer_load_dwordx4 v[164:167], v3, s[48:51], s74 offen offset:1024 nt
    v_and_b32_dpp v28, v14, v8 row_newbcast:0 row_mask:0xf bank_mask:0xf
    v_and_b32_dpp v29, v14, v9 row_newbcast:0 row_mask:0xf bank_mask:0xf
    v_and_b32_dpp v30, v14, v10 row_newbcast:0 row_mask:0xf bank_mask:0xf
    v_and_b32_dpp v31, v14, v11 row_newbcast:0 row_mask:0xf bank_mask:0xf
    s_waitcnt vmcnt(2)
    v_mfma_f32_16x16x32_bf16 v[20:23], v[32:35], v[156:159], v[20:23]
    buffer_load_dwordx4 v[168:171], v3, s[48:51], s74 offen offset:2048 nt
    v_and_b32_dpp v32, v14, v8 row_newbcast:4 row_mask:0xf bank_mask:0xf
    v_and_b32_dpp v33, v14, v9 row_newbcast:4 row_mask:0xf bank_mask:0xf
    v_and_b32_dpp v34, v14, v10 row_newbcast:4 row_mask:0xf bank_mask:0xf
    v_and_b32_dpp v35, v14, v11 row_newbcast:4 row_mask:0xf bank_mask:0xf
    s_waitcnt vmcnt(2)
    v_mfma_f32_16x16x32_bf16 v[20:23], v[28:31], v[160:163], v[20:23]
    v_and_b32 v61, 31, v0
    v_lshlrev_b32 v61, 2, v61
    buffer_load_dword v60, v61, s[60:63], s38 offen offset:128 sc1
    v_and_b32_dpp v28, v14, v8 row_newbcast:8 row_mask:0xf bank_mask:0xf
    v_and_b32_dpp v29, v14, v9 row_newbcast:8 row_mask:0xf bank_mask:0xf
    v_and_b32_dpp v30, v14, v10 row_newbcast:8 row_mask:0xf bank_mask:0xf
    v_and_b32_dpp v31, v14, v11 row_newbcast:8 row_mask:0xf bank_mask:0xf
    s_waitcnt vmcnt(2)
    v_mfma_f32_16x16x32_bf16 v[20:23], v[32:35], v[164:167], v[20:23]
    buffer_load_dwordx4 v[172:175], v3, s[48:51], s74 offen offset:3072 nt
    v_and_b32_dpp v32, v14, v8 row_newbcast:12 row_mask:0xf bank_mask:0xf
    v_and_b32_dpp v33, v14, v9 row_newbcast:12 row_mask:0xf bank_mask:0xf
    v_and_b32_dpp v34, v14, v10 row_newbcast:12 row_mask:0xf bank_mask:0xf
    v_and_b32_dpp v35, v14, v11 row_newbcast:12 row_mask:0xf bank_mask:0xf
    s_waitcnt vmcnt(2)
    v_mfma_f32_16x16x32_bf16 v[20:23], v[28:31], v[168:171], v[20:23]
    buffer_load_dwordx4 v[176:179], v3, s[48:51], s75 offen offset:0 nt
    s_waitcnt vmcnt(2)
    buffer_load_dwordx4 v[180:183], v3, s[48:51], s75 offen offset:1024 nt
    v_and_b32_dpp v28, v15, v8 row_newbcast:0 row_mask:0xf bank_mask:0xf
    v_and_b32_dpp v29, v15, v9 row_newbcast:0 row_mask:0xf bank_mask:0xf
    v_and_b32_dpp v30, v15, v10 row_newbcast:0 row_mask:0xf bank_mask:0xf
    v_and_b32_dpp v31, v15, v11 row_newbcast:0 row_mask:0xf bank_mask:0xf
    s_waitcnt vmcnt(2)
    v_mfma_f32_16x16x32_bf16 v[20:23], v[32:35], v[172:175], v[20:23]
    buffer_load_dwordx4 v[184:187], v3, s[48:51], s75 offen offset:2048 nt
    v_and_b32_dpp v32, v15, v8 row_newbcast:4 row_mask:0xf bank_mask:0xf
    v_and_b32_dpp v33, v15, v9 row_newbcast:4 row_mask:0xf bank_mask:0xf
    v_and_b32_dpp v34, v15, v10 row_newbcast:4 row_mask:0xf bank_mask:0xf
    v_and_b32_dpp v35, v15, v11 row_newbcast:4 row_mask:0xf bank_mask:0xf
    s_waitcnt vmcnt(2)
    v_mfma_f32_16x16x32_bf16 v[20:23], v[28:31], v[176:179], v[20:23]
    buffer_load_dwordx4 v[188:191], v3, s[48:51], s75 offen offset:3072 nt
    v_and_b32_dpp v28, v15, v8 row_newbcast:8 row_mask:0xf bank_mask:0xf
    v_and_b32_dpp v29, v15, v9 row_newbcast:8 row_mask:0xf bank_mask:0xf
    v_and_b32_dpp v30, v15, v10 row_newbcast:8 row_mask:0xf bank_mask:0xf
    v_and_b32_dpp v31, v15, v11 row_newbcast:8 row_mask:0xf bank_mask:0xf
    s_waitcnt vmcnt(2)
    v_mfma_f32_16x16x32_bf16 v[20:23], v[32:35], v[180:183], v[20:23]
L_xchk:
    v_xor_b32 v6, s0, v60
    v_cmp_lt_u32 vcc, 31, v6
    s_nop 0
    s_cbranch_vccz L_xok
    buffer_load_dword v60, v61, s[60:63], s38 offen offset:128 sc1
    s_waitcnt vmcnt(0)
    s_sleep 2
    s_sub_u32 s9, s9, 1
    s_cbranch_scc0 L_xchk
    s_branch L_end
L_xok:
    v_cmp_lt_u32 vcc, 15, v6
    v_and_b32 v6, 15, v6
    s_bcnt1_i32_b32 s20, vcc_lo
    v_cmp_ne_u32 vcc, 0, v6
    s_nop 0
    s_cmp_eq_u64 vcc, 0
    s_cselect_b32 s1, 1, 0
    v_and_b32 v6, 1, v0
    v_lshlrev_b32 v6, 4, v6
    v_lshrrev_b32 v6, v6, s76
    v_and_b32 v64, 15, v6
    v_bfe_u32 v65, v6, 4, 4
    v_bfe_u32 v66, v6, 8, 4
    v_bfe_u32 v67, v6, 12, 4
    v_lshlrev_b32 v61, 2, v1
    v_lshlrev_b32 v48, 5, v47
    v_lshl_add_u32 v48, v46, 4, v48
    s_lshl_b32 s11, s5, 9
    v_add_u32 v48, s11, v48
    v_bfe_u32 v7, v0, 5, 1
    v_lshlrev_b32 v49, 3, v1
    v_lshrrev_b32 v6, 2, v1
    v_lshlrev_b32 v50, 7, v6
    v_and_b32 v6, 3, v0
    v_lshl_add_u32 v50, v6, 2, v50
    s_bfe_u32 s11, s2, 0x20003
    s_lshl_b32 s11, s11, 7
    s_add_u32 s11, s11, s4
    s_lshl_b32 s11, s11, 4
    v_add_u32 v50, s11, v50
    s_mul_i32 s71, s5, 1280
    s_add_u32 s71, s71, s82
    s_add_u32 s71, s71, 8192
    v_and_b32 v5, 7, v0
    v_bfe_u32 v6, v0, 3, 1
    s_and_b32 s10, s2, 7
    s_and_b32 s11, s5, 3
    s_cmp_eq_u32 s6, 3
    s_cbranch_scc0 L_tsffn
    v_lshlrev_b32 v51, 4, v5
    v_lshl_add_u32 v51, v6, 9, v51
    v_lshl_add_u32 v51, v46, 7, v51
    s_cmp_ge_u32 s7, 10
    s_cselect_b32 s68, 4096, 0
    s_add_u32 s68, s68, s82
    v_bfe_u32 v52, v0, 3, 2
    v_xor_b32 v52, s11, v52
    v_lshlrev_b32 v52, 5, v52
    v_and_b32 v53, 3, v0
    v_lshl_add_u32 v52, v53, 3, v52
    v_bfe_u32 v55, v0, 2, 2
    v_lshl_add_u32 v52, v55, 7, v52
    v_lshl_add_u32 v52, v46, 10, v52
    v_add_u32 v52, 34816, v52
    s_mul_i32 s85, s5, 20
    s_add_u32 s85, s85, s7
    s_cmp_lt_u32 s10, 2
    s_cselect_b32 s13, 32, 16
    s_cmp_lt_u32 s85, s13
    s_cselect_b32 s83, 1, 0
    s_cselect_b32 s85, s85, 0
    s_cmp_lt_u32 s85, 16
    s_cselect_b32 s13, 0, 112
    s_add_u32 s85, s85, s13
    s_lshl_b32 s13, s10, 4
    s_add_u32 s85, s85, s13
    v_bfe_u32 v5, v0, 4, 1
    v_lshl_add_u32 v5, v5, 2, v53
    v_mul_u32_u24 v71, 1280, v5
    v_lshl_add_u32 v71, v7, 2, v71
    v_lshlrev_b32 v104, 4, v5
    v_lshl_add_u32 v104, v7, 2, v104
    v_lshrrev_b32 v5, 1, v47
    v_lshlrev_b32 v57, 4, v5
    v_mul_u32_u24 v56, 1280, v5
    v_and_b32 v5, 1, v0
    v_lshl_add_u32 v56, v5, 2, v56
    s_lshl_b32 s12, s7, 6
    s_lshl_b32 s13, s5, 3
    s_add_u32 s12, s12, s13
    s_lshl_b32 s13, s85, 3
    v_add_u32 v56, s13, v56
    v_add_u32 v71, s12, v71
    v_lshl_add_u32 v58, v5, 2, v57
    v_lshl_add_u32 v58, v7, 1, v58
    s_lshr_b32 s12, s85, 1
    s_lshl_b32 s12, s12, 7
    s_and_b32 s13, s85, 1
    s_lshl_b32 s13, s13, 3
    s_add_u32 s12, s12, s13
    v_add_u32 v58, s12, v58
    s_lshl_b32 s70, s7, 9
    s_lshr_b32 s12, s5, 1
    s_lshl_b32 s12, s12, 7
    s_add_u32 s70, s70, s12
    s_and_b32 s12, s5, 1
    s_lshl_b32 s12, s12, 3
    s_add_u32 s70, s70, s12
    s_add_u32 s70, s70, s82
    s_add_u32 s70, s70, 8192
    ds_read_b32 v59, v71 offset:10496
    v_mov_b32 v62, 0
    v_mov_b32 v63, 0
    s_cmp_gt_u32 s20, 16
    s_cselect_b32 s86, 8192, 0
    v_and_b32 v5, 7, v0
    v_lshlrev_b32 v54, 4, v5
    v_lshl_add_u32 v54, v46, 11, v54
    v_lshl_add_u32 v54, v6, 13, v54
    s_cmp_ge_u32 s7, 10
    s_cselect_b32 s12, -654336, 0
    s_lshl_b32 s69, s7, 16
    s_add_u32 s69, s69, s12
    s_lshl_b32 s12, s11, 14
    s_add_u32 s69, s69, s12
    s_lshl_b32 s12, s10, 7
    s_add_u32 s69, s69, s12
    s_add_u32 s69, s69, 327680
    v_bfe_u32 v70, v0, 2, 2
    v_lshl_add_u32 v70, v7, 2, v70
    v_lshlrev_b32 v70, 7, v70
    v_bfe_u32 v5, v0, 4, 1
    v_lshl_add_u32 v5, v5, 2, v53
    v_lshl_add_u32 v70, v5, 4, v70
    s_lshl_b32 s12, s7, 15
    s_lshr_b32 s13, s5, 2
    s_lshl_b32 s13, s13, 14
    s_add_u32 s12, s12, s13
    s_lshl_b32 s13, s11, 11
    s_add_u32 s12, s12, s13
    s_add_u32 s12, s12, s86
    s_add_u32 s12, s12, 327680
    v_add_u32 v70, s12, v70
    s_movk_i32 s84, 1024
    v_lshlrev_b32 v55, 3, v1
    s_lshr_b32 s12, s85, 3
    s_lshl_b32 s12, s12, 14
    s_and_b32 s13, s85, 7
    s_lshl_b32 s13, s13, 10
    s_add_u32 s12, s12, s13
    s_add_u32 s12, s12, s86
    s_add_u32 s12, s12, 1179648
    v_add_u32 v55, s12, v55
    v_add_u32 v69, 512, v55
    s_cmp_eq_u32 s83, 0
    s_cbranch_scc1 L_tsdone
    s_mov_b64 exec, 0x3ff
    v_lshlrev_b32 v6, 7, v1
    global_load_dword v45, v6, s[28:29]
    s_mov_b64 exec, -1
    s_branch L_tsdone
L_tsffn:
    s_cmp_eq_u32 s6, 2
    s_cbranch_scc1 L_tsdown
    v_lshlrev_b32 v52, 4, v5
    s_lshr_b32 s12, s5, 2
    s_lshl_b32 s12, s12, 7
    s_lshl_b32 s13, s11, 2
    s_add_u32 s12, s12, s13
    v_add_u32 v51, s12, v52
    v_lshl_add_u32 v55, v6, 9, v52
    v_lshl_add_u32 v55, v46, 7, v55
    v_lshl_add_u32 v53, v6, 23, v55
    s_mul_i32 s69, s11, 2560
    s_add_u32 s69, s69, s82
    s_add_u32 s69, s69, 8192
    s_mul_i32 s12, s5, 1056
    v_add_u32 v56, s12, v44
    v_lshlrev_b32 v57, 4, v5
    v_mul_u32_u24 v6, 4224, v6
    v_add_u32 v57, v57, v6
    v_bfe_u32 v6, v0, 4, 1
    v_lshl_add_u32 v57, v6, 3, v57
    v_lshl_add_u32 v57, v7, 8, v57
    s_lshr_b32 s12, s11, 1
    s_lshl_b32 s12, s12, 7
    s_and_b32 s13, s11, 1
    s_lshl_b32 s13, s13, 9
    s_add_u32 s12, s12, s13
    v_add_u32 v57, s12, v57
    v_bfe_u32 v58, v0, 2, 2
    v_lshlrev_b32 v58, 6, v58
    v_and_b32 v6, 3, v0
    v_lshl_add_u32 v58, v6, 3, v58
    v_lshl_add_u32 v58, v46, 9, v58
    v_bfe_u32 v6, v0, 4, 1
    v_lshl_add_u32 v58, v6, 5, v58
    v_add_u32 v58, s42, v58
    v_xor_b32 v60, 32, v58
    v_lshlrev_b32 v59, 4, v5
    v_lshl_add_u32 v59, v46, 2, v59
    s_lshl_b32 s70, s7, 9
    s_lshl_b32 s12, s11, 7
    s_add_u32 s70, s70, s12
    s_branch L_tsdone
L_tsdown:
    v_lshlrev_b32 v51, 4, v5
    v_lshl_add_u32 v51, v6, 9, v51
    v_lshl_add_u32 v51, v46, 7, v51
    s_lshl_b32 s12, s11, 2
    v_bfe_u32 v52, v0, 1, 1
    v_add_u32 v52, s12, v52
    v_bfe_u32 v53, v0, 2, 2
    v_lshlrev_b32 v54, 1, v53
    v_xor_b32 v52, v52, v54
    v_lshlrev_b32 v52, 4, v52
    v_lshl_add_u32 v52, v53, 8, v52
    v_and_b32 v53, 1, v0
    v_lshl_add_u32 v52, v53, 3, v52
    v_lshl_add_u32 v52, v46, 14, v52
    v_add_u32 v52, 34816, v52
    v_xor_b32 v53, 32, v52
    v_xor_b32 v57, 128, v52
    v_xor_b32 v58, 160, v52
    v_lshlrev_b32 v54, 4, v5
    v_lshl_add_u32 v54, v46, 10, v54
    v_lshl_add_u32 v54, v6, 12, v54
    s_lshl_b32 s69, s7, 16
    s_lshl_b32 s12, s11, 14
    s_add_u32 s69, s69, s12
    s_lshl_b32 s12, s10, 7
    s_add_u32 s69, s69, s12
    s_add_u32 s69, s69, 1572864
    s_xor_b32 s70, s69, 8192
    s_lshl_b32 s11, s7, 3
    s_add_u32 s11, s11, s5
    s_and_b32 s11, s11, 31
    s_mul_i32 s10, s10, 448
    s_and_b32 s10, s10, -128
    s_min_u32 s10, s10, 2944
    s_bfe_u32 s12, s11, 0x30001
    s_mul_i32 s12, s12, 276480
    s_add_u32 s10, s10, s12
    s_and_b32 s12, s11, 1
    s_mul_i32 s12, s12, 27648
    s_add_u32 s10, s10, s12
    s_add_u32 s10, s10, 221184
    s_cmp_lt_u32 s11, 16
    s_cselect_b32 s84, s30, s32
    s_cselect_b32 s85, s31, s33
    s_add_u32 s84, s84, s10
    s_addc_u32 s85, s85, 0
    v_lshrrev_b32 v6, 2, v1
    v_mul_u32_u24 v6, 3456, v6
    v_and_b32 v7, 3, v0
    v_lshl_add_u32 v69, v7, 7, v6
L_tsdone:
    v_xor_b32 v3, 0x20000, v3
    buffer_load_dwordx4 v[192:195], v3, s[48:51], s72 offen offset:0 nt
    v_and_b32_dpp v32, v15, v8 row_newbcast:12 row_mask:0xf bank_mask:0xf
    v_and_b32_dpp v33, v15, v9 row_newbcast:12 row_mask:0xf bank_mask:0xf
    v_and_b32_dpp v34, v15, v10 row_newbcast:12 row_mask:0xf bank_mask:0xf
    v_and_b32_dpp v35, v15, v11 row_newbcast:12 row_mask:0xf bank_mask:0xf
    s_waitcnt vmcnt(2)
    v_mfma_f32_16x16x32_bf16 v[20:23], v[28:31], v[184:187], v[20:23]
    buffer_load_dwordx4 v[196:199], v3, s[48:51], s72 offen offset:1024 nt
    v_and_b32_dpp v28, v16, v8 row_newbcast:0 row_mask:0xf bank_mask:0xf
    v_and_b32_dpp v29, v16, v9 row_newbcast:0 row_mask:0xf bank_mask:0xf
    v_and_b32_dpp v30, v16, v10 row_newbcast:0 row_mask:0xf bank_mask:0xf
    v_and_b32_dpp v31, v16, v11 row_newbcast:0 row_mask:0xf bank_mask:0xf
    s_waitcnt vmcnt(2)
    v_mfma_f32_16x16x32_bf16 v[20:23], v[32:35], v[188:191], v[20:23]
    buffer_load_dwordx4 v[200:203], v3, s[48:51], s72 offen offset:2048 nt
    v_and_b32_dpp v32, v16, v8 row_newbcast:4 row_mask:0xf bank_mask:0xf
    v_and_b32_dpp v33, v16, v9 row_newbcast:4 row_mask:0xf bank_mask:0xf
    v_and_b32_dpp v34, v16, v10 row_newbcast:4 row_mask:0xf bank_mask:0xf
    v_and_b32_dpp v35, v16, v11 row_newbcast:4 row_mask:0xf bank_mask:0xf
    s_waitcnt vmcnt(2)
    v_mfma_f32_16x16x32_bf16 v[20:23], v[28:31], v[192:195], v[20:23]
    buffer_load_dwordx4 v[204:207], v3, s[48:51], s72 offen offset:3072 nt
    v_and_b32_dpp v28, v16, v8 row_newbcast:8 row_mask:0xf bank_mask:0xf
    v_and_b32_dpp v29, v16, v9 row_newbcast:8 row_mask:0xf bank_mask:0xf
    v_and_b32_dpp v30, v16, v10 row_newbcast:8 row_mask:0xf bank_mask:0xf
    v_and_b32_dpp v31, v16, v11 row_newbcast:8 row_mask:0xf bank_mask:0xf
    s_waitcnt vmcnt(2)
    v_mfma_f32_16x16x32_bf16 v[20:23], v[32:35], v[196:199], v[20:23]
    s_getpc_b64 s[14:15]
L_pc2:
    s_lshr_b32 s10, s2, 3
    s_and_b32 s10, s10, 15
    s_lshl_b32 s10, s10, 3
    s_add_u32 s10, s10, s5
    s_lshl_b32 s10, s10, 7
    s_min_u32 s10, s10, L_end-L_pc2-4
    v_mov_b32 v6, s10
    s_mov_b64 exec, 1
    global_load_dword v45, v6, s[14:15]
    s_mov_b64 exec, -1
    v_and_b32_dpp v32, v16, v8 row_newbcast:12 row_mask:0xf bank_mask:0xf
    v_and_b32_dpp v33, v16, v9 row_newbcast:12 row_mask:0xf bank_mask:0xf
    v_and_b32_dpp v34, v16, v10 row_newbcast:12 row_mask:0xf bank_mask:0xf
    v_and_b32_dpp v35, v16, v11 row_newbcast:12 row_mask:0xf bank_mask:0xf
    s_waitcnt vmcnt(2)
    v_mfma_f32_16x16x32_bf16 v[20:23], v[28:31], v[200:203], v[20:23]
    buffer_load_dwordx4 v[208:211], v3, s[48:51], s73 offen offset:0 nt
    v_and_b32_dpp v28, v17, v8 row_newbcast:0 row_mask:0xf bank_mask:0xf
    v_and_b32_dpp v29, v17, v9 row_newbcast:0 row_mask:0xf bank_mask:0xf
    v_and_b32_dpp v30, v17, v10 row_newbcast:0 row_mask:0xf bank_mask:0xf
    v_and_b32_dpp v31, v17, v11 row_newbcast:0 row_mask:0xf bank_mask:0xf
    s_waitcnt vmcnt(2)
    v_mfma_f32_16x16x32_bf16 v[20:23], v[32:35], v[204:207], v[20:23]
    buffer_load_dwordx4 v[212:215], v3, s[48:51], s73 offen offset:1024 nt
    s_waitcnt vmcnt(2)
    buffer_load_dwordx4 v[216:219], v3, s[48:51], s73 offen offset:2048 nt
    v_and_b32_dpp v32, v17, v8 row_newbcast:4 row_mask:0xf bank_mask:0xf
    v_and_b32_dpp v33, v17, v9 row_newbcast:4 row_mask:0xf bank_mask:0xf
    v_and_b32_dpp v34, v17, v10 row_newbcast:4 row_mask:0xf bank_mask:0xf
    v_and_b32_dpp v35, v17, v11 row_newbcast:4 row_mask:0xf bank_mask:0xf
    s_waitcnt vmcnt(2)
    v_mfma_f32_16x16x32_bf16 v[20:23], v[28:31], v[208:211], v[20:23]
    buffer_load_dwordx4 v[220:223], v3, s[48:51], s73 offen offset:3072 nt
    v_and_b32_dpp v28, v17, v8 row_newbcast:8 row_mask:0xf bank_mask:0xf
    v_and_b32_dpp v29, v17, v9 row_newbcast:8 row_mask:0xf bank_mask:0xf
    v_and_b32_dpp v30, v17, v10 row_newbcast:8 row_mask:0xf bank_mask:0xf
    v_and_b32_dpp v31, v17, v11 row_newbcast:8 row_mask:0xf bank_mask:0xf
    s_waitcnt vmcnt(2)
    v_mfma_f32_16x16x32_bf16 v[20:23], v[32:35], v[212:215], v[20:23]
    buffer_load_dwordx4 v[224:227], v3, s[48:51], s74 offen offset:0 nt
    v_and_b32_dpp v32, v17, v8 row_newbcast:12 row_mask:0xf bank_mask:0xf
    v_and_b32_dpp v33, v17, v9 row_newbcast:12 row_mask:0xf bank_mask:0xf
    v_and_b32_dpp v34, v17, v10 row_newbcast:12 row_mask:0xf bank_mask:0xf
    v_and_b32_dpp v35, v17, v11 row_newbcast:12 row_mask:0xf bank_mask:0xf
    s_waitcnt vmcnt(2)
    v_mfma_f32_16x16x32_bf16 v[20:23], v[28:31], v[216:219], v[20:23]
    buffer_load_dwordx4 v[228:231], v3, s[48:51], s74 offen offset:1024 nt
    v_and_b32_dpp v28, v18, v8 row_newbcast:0 row_mask:0xf bank_mask:0xf
    v_and_b32_dpp v29, v18, v9 row_newbcast:0 row_mask:0xf bank_mask:0xf
    v_and_b32_dpp v30, v18, v10 row_newbcast:0 row_mask:0xf bank_mask:0xf
    v_and_b32_dpp v31, v18, v11 row_newbcast:0 row_mask:0xf bank_mask:0xf
    s_waitcnt vmcnt(2)
    v_mfma_f32_16x16x32_bf16 v[20:23], v[32:35], v[220:223], v[20:23]
    buffer_load_dwordx4 v[232:235], v3, s[48:51], s74 offen offset:2048 nt
    v_and_b32_dpp v32, v18, v8 row_newbcast:4 row_mask:0xf bank_mask:0xf
    v_and_b32_dpp v33, v18, v9 row_newbcast:4 row_mask:0xf bank_mask:0xf
    v_and_b32_dpp v34, v18, v10 row_newbcast:4 row_mask:0xf bank_mask:0xf
    v_and_b32_dpp v35, v18, v11 row_newbcast:4 row_mask:0xf bank_mask:0xf
    s_waitcnt vmcnt(2)
    v_mfma_f32_16x16x32_bf16 v[20:23], v[28:31], v[224:227], v[20:23]
    buffer_load_dwordx4 v[236:239], v3, s[48:51], s74 offen offset:3072 nt
    v_and_b32_dpp v28, v18, v8 row_newbcast:8 row_mask:0xf bank_mask:0xf
    v_and_b32_dpp v29, v18, v9 row_newbcast:8 row_mask:0xf bank_mask:0xf
    v_and_b32_dpp v30, v18, v10 row_newbcast:8 row_mask:0xf bank_mask:0xf
    v_and_b32_dpp v31, v18, v11 row_newbcast:8 row_mask:0xf bank_mask:0xf
    s_waitcnt vmcnt(2)
    v_mfma_f32_16x16x32_bf16 v[20:23], v[32:35], v[228:231], v[20:23]
    buffer_load_dwordx4 v[240:243], v3, s[48:51], s75 offen offset:0 nt
    v_and_b32_dpp v32, v18, v8 row_newbcast:12 row_mask:0xf bank_mask:0xf
    v_and_b32_dpp v33, v18, v9 row_newbcast:12 row_mask:0xf bank_mask:0xf
    v_and_b32_dpp v34, v18, v10 row_newbcast:12 row_mask:0xf bank_mask:0xf
    v_and_b32_dpp v35, v18, v11 row_newbcast:12 row_mask:0xf bank_mask:0xf
    s_waitcnt vmcnt(2)
    v_mfma_f32_16x16x32_bf16 v[20:23], v[28:31], v[232:235], v[20:23]
    buffer_load_dwordx4 v[244:247], v3, s[48:51], s75 offen offset:1024 nt
    v_and_b32_dpp v28, v19, v8 row_newbcast:0 row_mask:0xf bank_mask:0xf
    v_and_b32_dpp v29, v19, v9 row_newbcast:0 row_mask:0xf bank_mask:0xf
    v_and_b32_dpp v30, v19, v10 row_newbcast:0 row_mask:0xf bank_mask:0xf
    v_and_b32_dpp v31, v19, v11 row_newbcast:0 row_mask:0xf bank_mask:0xf
    s_waitcnt vmcnt(2)
    v_mfma_f32_16x16x32_bf16 v[20:23], v[32:35], v[236:239], v[20:23]
    buffer_load_dwordx4 v[248:251], v3, s[48:51], s75 offen offset:2048 nt
    v_and_b32_dpp v32, v19, v8 row_newbcast:4 row_mask:0xf bank_mask:0xf
    v_and_b32_dpp v33, v19, v9 row_newbcast:4 row_mask:0xf bank_mask:0xf
    v_and_b32_dpp v34, v19, v10 row_newbcast:4 row_mask:0xf bank_mask:0xf
    v_and_b32_dpp v35, v19, v11 row_newbcast:4 row_mask:0xf bank_mask:0xf
    s_waitcnt vmcnt(2)
    v_mfma_f32_16x16x32_bf16 v[20:23], v[28:31], v[240:243], v[20:23]
    buffer_load_dwordx4 v[252:255], v3, s[48:51], s75 offen offset:3072 nt
    s_cmp_eq_u32 s6, 3
    s_cbranch_scc1 L_pvwo
    s_cmp_eq_u32 s6, 1
    s_cbranch_scc1 L_pvc
    v_and_b32_dpp v28, v19, v8 row_newbcast:8 row_mask:0xf bank_mask:0xf
    v_and_b32_dpp v29, v19, v9 row_newbcast:8 row_mask:0xf bank_mask:0xf
    v_and_b32_dpp v30, v19, v10 row_newbcast:8 row_mask:0xf bank_mask:0xf
    v_and_b32_dpp v31, v19, v11 row_newbcast:8 row_mask:0xf bank_mask:0xf
    s_waitcnt vmcnt(2)
    v_mfma_f32_16x16x32_bf16 v[20:23], v[32:35], v[244:247], v[20:23]
    v_and_b32_dpp v32, v19, v8 row_newbcast:12 row_mask:0xf bank_mask:0xf
    v_and_b32_dpp v33, v19, v9 row_newbcast:12 row_mask:0xf bank_mask:0xf
    v_and_b32_dpp v34, v19, v10 row_newbcast:12 row_mask:0xf bank_mask:0xf
    v_and_b32_dpp v35, v19, v11 row_newbcast:12 row_mask:0xf bank_mask:0xf
    s_waitcnt vmcnt(1)
    v_mfma_f32_16x16x32_bf16 v[20:23], v[28:31], v[248:251], v[20:23]
    s_waitcnt vmcnt(0)
    v_mfma_f32_16x16x32_bf16 v[20:23], v[32:35], v[252:255], v[20:23]
    s_branch L_pvdone
L_pvc:
    v_and_b32_dpp v28, v19, v8 row_newbcast:8 row_mask:0xf bank_mask:0xf
    v_and_b32_dpp v29, v19, v9 row_newbcast:8 row_mask:0xf bank_mask:0xf
    v_and_b32_dpp v30, v19, v10 row_newbcast:8 row_mask:0xf bank_mask:0xf
    v_and_b32_dpp v31, v19, v11 row_newbcast:8 row_mask:0xf bank_mask:0xf
    s_waitcnt vmcnt(2)
    v_mfma_f32_16x16x32_bf16 v[20:23], v[32:35], v[244:247], v[20:23]
    s_mov_b32 m0, s23
    s_add_u32 s23, s23, 1024
    buffer_load_dwordx4 v4, s[56:59], s8 offen  lds
    s_add_u32 s8, s8, s43
    v_and_b32_dpp v32, v19, v8 row_newbcast:12 row_mask:0xf bank_mask:0xf
    v_and_b32_dpp v33, v19, v9 row_newbcast:12 row_mask:0xf bank_mask:0xf
    v_and_b32_dpp v34, v19, v10 row_newbcast:12 row_mask:0xf bank_mask:0xf
    v_and_b32_dpp v35, v19, v11 row_newbcast:12 row_mask:0xf bank_mask:0xf
    s_waitcnt vmcnt(2)
    v_mfma_f32_16x16x32_bf16 v[20:23], v[28:31], v[248:251], v[20:23]
    s_mov_b32 m0, s23
    s_add_u32 s23, s23, 1024
    buffer_load_dwordx4 v4, s[56:59], s8 offen  lds
    s_add_u32 s8, s8, s43
    s_waitcnt vmcnt(2)
    v_mfma_f32_16x16x32_bf16 v[20:23], v[32:35], v[252:255], v[20:23]
    s_branch L_pvdone
L_pvwo:
    s_mov_b32 m0, s23
    s_add_u32 s23, s23, 1024
    buffer_load_dwordx4 v4, s[56:59], s8 offen nt lds
    v_xor_b32 v4, 64, v4
    s_add_u32 s8, s8, s43
    v_and_b32_dpp v28, v19, v8 row_newbcast:8 row_mask:0xf bank_mask:0xf
    v_and_b32_dpp v29, v19, v9 row_newbcast:8 row_mask:0xf bank_mask:0xf
    v_and_b32_dpp v30, v19, v10 row_newbcast:8 row_mask:0xf bank_mask:0xf
    v_and_b32_dpp v31, v19, v11 row_newbcast:8 row_mask:0xf bank_mask:0xf
    s_waitcnt vmcnt(3)
    v_mfma_f32_16x16x32_bf16 v[20:23], v[32:35], v[244:247], v[20:23]
    s_mov_b32 m0, s23
    s_add_u32 s23, s23, 1024
    buffer_load_dwordx4 v4, s[56:59], s8 offen nt lds
    v_xor_b32 v4, 64, v4
    s_add_u32 s8, s8, s43
    v_and_b32_dpp v32, v19, v8 row_newbcast:12 row_mask:0xf bank_mask:0xf
    v_and_b32_dpp v33, v19, v9 row_newbcast:12 row_mask:0xf bank_mask:0xf
    v_and_b32_dpp v34, v19, v10 row_newbcast:12 row_mask:0xf bank_mask:0xf
    v_and_b32_dpp v35, v19, v11 row_newbcast:12 row_mask:0xf bank_mask:0xf
    s_waitcnt vmcnt(3)
    v_mfma_f32_16x16x32_bf16 v[20:23], v[28:31], v[248:251], v[20:23]
    s_mov_b32 m0, s23
    s_add_u32 s23, s23, 1024
    buffer_load_dwordx4 v4, s[56:59], s8 offen nt lds
    v_xor_b32 v4, 64, v4
    s_add_u32 s8, s8, s43
    s_waitcnt vmcnt(3)
    v_mfma_f32_16x16x32_bf16 v[20:23], v[32:35], v[252:255], v[20:23]
    s_mov_b32 m0, s23
    s_add_u32 s23, s23, 1024
    buffer_load_dwordx4 v4, s[56:59], s8 offen nt lds
    v_xor_b32 v4, 64, v4
    s_add_u32 s8, s8, s43
L_pvdone:
    s_cmp_eq_u32 s5, 0
    s_mov_b32 exec_hi, 0
    s_nop 4
    ds_write_b128 v48, v[20:23] offset:20992
    s_mov_b64 exec, -1
    s_waitcnt lgkmcnt(0)
    s_barrier
    s_cbranch_scc0 L_noopub
    ds_read2st64_b64 v[128:131], v49 offset0:41 offset1:42
    ds_read2st64_b64 v[132:135], v49 offset0:43 offset1:44
    ds_read2st64_b64 v[136:139], v49 offset0:45 offset1:46
    ds_read2st64_b64 v[140:143], v49 offset0:47 offset1:48
    s_cmp_eq_u32 s1, 1
    s_waitcnt lgkmcnt(2)
    v_pk_add_f32 v[128:129], v[128:129], v[130:131]
    v_pk_add_f32 v[132:133], v[132:133], v[134:135]
    v_pk_add_f32 v[128:129], v[128:129], v[132:133]
    s_waitcnt lgkmcnt(0)
    v_pk_add_f32 v[136:137], v[136:137], v[138:139]
    v_pk_add_f32 v[140:141], v[140:141], v[142:143]
    v_pk_add_f32 v[128:129], v[128:129], v[136:137]
    v_pk_add_f32 v[128:129], v[128:129], v[140:141]
    v_cvt_pk_bf16_f32 v128, v128, v129
    v_min_u32 v128, -2, v128
    s_cbranch_scc0 L_ls3
    buffer_store_dword v128, v50, s[60:63], s82 offen
L_le3:
L_noopub:
    s_cmp_eq_u32 s6, 3
    s_cbranch_scc0 L_ffn
    s_cmp_eq_u32 s5, 0
    s_cbranch_scc1 L_w0
    s_waitcnt vmcnt(0)
L_w0:
    s_waitcnt vmcnt(1)
    s_cmp_lt_u32 s5, 4
    s_barrier
    s_cbranch_scc1 L_low
    buffer_load_dwordx4 v[128:131], v51, s[60:63], s68 offen offset:0 sc1
    buffer_load_dwordx4 v[132:135], v51, s[60:63], s68 offen offset:1024 sc1
    buffer_load_dwordx4 v[136:139], v51, s[60:63], s68 offen offset:2048 sc1
    buffer_load_dwordx4 v[140:143], v51, s[60:63], s68 offen offset:3072 sc1
    ds_read_b64_tr_b16 v[72:73], v52 offset:0
    ds_read_b64_tr_b16 v[74:75], v52 offset:512
    ds_read_b64_tr_b16 v[76:77], v52 offset:4096
    ds_read_b64_tr_b16 v[78:79], v52 offset:4608
    ds_read_b64_tr_b16 v[80:81], v52 offset:8192
    ds_read_b64_tr_b16 v[82:83], v52 offset:8704
    ds_read_b64_tr_b16 v[84:85], v52 offset:12288
    ds_read_b64_tr_b16 v[86:87], v52 offset:12800
    ds_read_b64_tr_b16 v[88:89], v52 offset:16384
    ds_read_b64_tr_b16 v[90:91], v52 offset:16896
    ds_read_b64_tr_b16 v[92:93], v52 offset:20480
    ds_read_b64_tr_b16 v[94:95], v52 offset:20992
    ds_read_b64_tr_b16 v[96:97], v52 offset:24576
    ds_read_b64_tr_b16 v[98:99], v52 offset:25088
    s_waitcnt lgkmcnt(8)
    ds_read_b64_tr_b16 v[100:101], v52 offset:28672
    ds_read_b64_tr_b16 v[102:103], v52 offset:29184
    s_branch L_ochk
L_opoll:
    s_sub_u32 s9, s9, 1
    s_cbranch_scc1 L_end
    buffer_load_dwordx4 v[128:131], v51, s[60:63], s68 offen offset:0 sc1
    buffer_load_dwordx4 v[132:135], v51, s[60:63], s68 offen offset:1024 sc1
    buffer_load_dwordx4 v[136:139], v51, s[60:63], s68 offen offset:2048 sc1
    buffer_load_dwordx4 v[140:143], v51, s[60:63], s68 offen offset:3072 sc1
L_ochk:
    s_waitcnt vmcnt(3) lgkmcnt(0)
    v_max3_u32 v6, v128, v129, v130
    v_max_u32 v6, v6, v131
    s_waitcnt vmcnt(2)
    v_max3_u32 v6, v6, v132, v133
    v_max3_u32 v6, v6, v134, v135
    s_waitcnt vmcnt(1)
    v_max3_u32 v6, v6, v136, v137
    v_max3_u32 v6, v6, v138, v139
    s_waitcnt vmcnt(0)
    v_max3_u32 v6, v6, v140, v141
    v_max3_u32 v6, v6, v142, v143
    v_cmp_eq_u32 vcc, -1, v6
    s_nop 0
    s_cbranch_vccnz L_opoll
    v_mfma_f32_16x16x32_bf16 v[144:147], v[72:75], v[128:131], 0
    v_mfma_f32_16x16x32_bf16 v[148:151], v[76:79], v[128:131], 0
    v_mfma_f32_16x16x32_bf16 v[144:147], v[80:83], v[132:135], v[144:147]
    v_mfma_f32_16x16x32_bf16 v[148:151], v[84:87], v[132:135], v[148:151]
    v_mfma_f32_16x16x32_bf16 v[144:147], v[88:91], v[136:139], v[144:147]
    v_mfma_f32_16x16x32_bf16 v[148:151], v[92:95], v[136:139], v[148:151]
    v_mfma_f32_16x16x32_bf16 v[144:147], v[96:99], v[140:143], v[144:147]
    v_mfma_f32_16x16x32_bf16 v[148:151], v[100:103], v[140:143], v[148:151]
    s_nop 7
    v_add_f32_dpp v152, v148, v144 row_ror:8 row_mask:0xf bank_mask:0x3
    v_add_f32_dpp v153, v149, v145 row_ror:8 row_mask:0xf bank_mask:0x3
    v_add_f32_dpp v154, v150, v146 row_ror:8 row_mask:0xf bank_mask:0x3
    v_add_f32_dpp v155, v151, v147 row_ror:8 row_mask:0xf bank_mask:0x3
    v_add_f32_dpp v152, v144, v148 row_ror:8 row_mask:0xf bank_mask:0xc
    v_add_f32_dpp v153, v145, v149 row_ror:8 row_mask:0xf bank_mask:0xc
    v_add_f32_dpp v154, v146, v150 row_ror:8 row_mask:0xf bank_mask:0xc
    v_add_f32_dpp v155, v147, v151 row_ror:8 row_mask:0xf bank_mask:0xc
    v_and_or_b32 v152, v152, -16, v64
    v_and_or_b32 v153, v153, -16, v65
    v_and_or_b32 v154, v154, -16, v66
    v_and_or_b32 v155, v155, -16, v67
    buffer_store_dwordx4 v[152:155], v54, s[60:63], s69 offen sc1
L_low:
    v_lshlrev_b32 v168, 16, v59
    v_and_b32 v169, 0xffff0000, v59
    s_barrier
    s_sleep 12
L_redpoll:
    buffer_load_dwordx4 v[160:163], v70, s[60:63], 0 offen sc1
    buffer_load_dwordx4 v[164:167], v70, s[60:63], s84 offen sc1
    s_waitcnt vmcnt(0)
    v_xor_b32 v160, v64, v160
    v_xor_b32 v161, v65, v161
    v_xor_b32 v162, v66, v162
    v_xor_b32 v163, v67, v163
    v_xor_b32 v164, v64, v164
    v_xor_b32 v165, v65, v165
    v_xor_b32 v166, v66, v166
    v_xor_b32 v167, v67, v167
    v_or3_b32 v6, v160, v161, v162
    v_or3_b32 v6, v6, v163, v164
    v_or3_b32 v6, v6, v165, v166
    v_or_b32 v6, v6, v167
    v_and_b32 v6, 15, v6
    v_cmp_ne_u32 vcc, 0, v6
    s_nop 0
    s_cbranch_vccz L_redok
    s_wqm_b64 exec, vcc
    buffer_load_dwordx4 v[184:187], v70, s[60:63], 0 offen sc1
    buffer_load_dwordx4 v[188:191], v70, s[60:63], s84 offen sc1
    s_sleep 3
    buffer_load_dwordx4 v[192:195], v70, s[60:63], 0 offen sc1
    buffer_load_dwordx4 v[196:199], v70, s[60:63], s84 offen sc1
    s_sleep 3
L_redpipe:
    buffer_load_dwordx4 v[200:203], v70, s[60:63], 0 offen sc1
    buffer_load_dwordx4 v[204:207], v70, s[60:63], s84 offen sc1
    s_waitcnt vmcnt(4)
    v_xor_b32 v160, v64, v184
    v_xor_b32 v161, v65, v185
    v_xor_b32 v162, v66, v186
    v_xor_b32 v163, v67, v187
    v_xor_b32 v164, v64, v188
    v_xor_b32 v165, v65, v189
    v_xor_b32 v166, v66, v190
    v_xor_b32 v167, v67, v191
    v_or3_b32 v6, v160, v161, v162
    v_or3_b32 v6, v6, v163, v164
    v_or3_b32 v6, v6, v165, v166
    v_or_b32 v6, v6, v167
    v_and_b32 v6, 15, v6
    v_cmp_ne_u32 vcc, 0, v6
    s_nop 0
    s_wqm_b64 exec, vcc
    s_cbranch_execz L_redok
    s_sleep 2
    buffer_load_dwordx4 v[184:187], v70, s[60:63], 0 offen sc1
    buffer_load_dwordx4 v[188:191], v70, s[60:63], s84 offen sc1
    s_waitcnt vmcnt(4)
    v_xor_b32 v160, v64, v192
    v_xor_b32 v161, v65, v193
    v_xor_b32 v162, v66, v194
    v_xor_b32 v163, v67, v195
    v_xor_b32 v164, v64, v196
    v_xor_b32 v165, v65, v197
    v_xor_b32 v166, v66, v198
    v_xor_b32 v167, v67, v199
    v_or3_b32 v6, v160, v161, v162
    v_or3_b32 v6, v6, v163, v164
    v_or3_b32 v6, v6, v165, v166
    v_or_b32 v6, v6, v167
    v_and_b32 v6, 15, v6
    v_cmp_ne_u32 vcc, 0, v6
    s_nop 0
    s_wqm_b64 exec, vcc
    s_cbranch_execz L_redok
    s_sleep 2
    buffer_load_dwordx4 v[192:195], v70, s[60:63], 0 offen sc1
    buffer_load_dwordx4 v[196:199], v70, s[60:63], s84 offen sc1
    s_waitcnt vmcnt(4)
    v_xor_b32 v160, v64, v200
    v_xor_b32 v161, v65, v201
    v_xor_b32 v162, v66, v202
    v_xor_b32 v163, v67, v203
    v_xor_b32 v164, v64, v204
    v_xor_b32 v165, v65, v205
    v_xor_b32 v166, v66, v206
    v_xor_b32 v167, v67, v207
    v_or3_b32 v6, v160, v161, v162
    v_or3_b32 v6, v6, v163, v164
    v_or3_b32 v6, v6, v165, v166
    v_or_b32 v6, v6, v167
    v_and_b32 v6, 15, v6
    v_cmp_ne_u32 vcc, 0, v6
    s_nop 0
    s_wqm_b64 exec, vcc
    s_cbranch_execz L_redok
    s_sleep 2
    s_sub_u32 s9, s9, 1
    s_cbranch_scc0 L_redpipe
    s_branch L_end
L_redok:
    s_mov_b64 exec, -1
    v_pk_add_f32 v[160:161], v[160:161], v[164:165]
    v_pk_add_f32 v[162:163], v[162:163], v[166:167]
    s_cmp_eq_u32 s1, 1
    s_nop 0
    v_permlane32_swap_b32 v160, v162
    v_permlane32_swap_b32 v161, v163
    v_add_f32 v160, v160, v162
    v_add_f32 v161, v161, v163
    s_nop 0
    v_add_f32_dpp v160, v160, v160 row_ror:8 row_mask:0xf bank_mask:0xf
    v_add_f32_dpp v161, v161, v161 row_ror:8 row_mask:0xf bank_mask:0xf
    s_nop 0
    v_add_f32_dpp v160, v160, v160 row_ror:4 row_mask:0xf bank_mask:0xf
    v_add_f32_dpp v161, v161, v161 row_ror:4 row_mask:0xf bank_mask:0xf
    v_cvt_pk_bf16_f32 v162, v160, v161
    v_lshlrev_b32 v160, 16, v162
    v_and_b32 v161, 0xffff0000, v162
    v_add_f32 v160, v160, v168
    v_add_f32 v161, v161, v169
    s_mov_b32 exec_lo, 0x000f000f
    s_mov_b32 exec_hi, 0x000f000f
    v_cvt_pk_bf16_f32 v160, v160, v161
    v_min_u32 v160, -2, v160
    s_cbranch_scc0 L_ls4
    buffer_store_dword v160, v104, s[60:63], s70 offen
L_le4:
    s_mov_b64 exec, -1
    s_xor_b32 s11, s5, 1
    s_or_b32 s11, s2, s11
    s_cbranch_scc1 L_nobump
    v_mov_b32 v6, 0
    v_mov_b32 v7, s26
    s_mov_b64 exec, 1
    global_store_dword v6, v7, s[40:41] sc1
    s_mov_b64 exec, -1
L_nobump:
    s_add_u32 s52, s40, 393216
    s_addc_u32 s53, s41, 0
    s_mul_i32 s11, s5, 1280
    v_add_u32 v70, s11, v44
    v_add_u32 v54, s11, v61
    global_load_dwordx4 v[64:67], v44, s[28:29]
    global_load_dword v68, v61, s[28:29] offset:1024
    s_waitcnt vmcnt(0)
L_epoll:
    buffer_load_dwordx4 v[184:187], v44, s[60:63], s71 offen sc1
    buffer_load_dword v188, v61, s[60:63], s71 offen offset:1024 sc1
    s_waitcnt vmcnt(0)
    v_max3_u32 v6, v184, v185, v186
    v_max3_u32 v6, v6, v187, v188
    v_cmp_eq_u32 vcc, -1, v6
    s_nop 0
    s_cbranch_vccz L_eok
    s_sleep 2
    s_sub_u32 s9, s9, 1
    s_cbranch_scc0 L_epoll
    s_branch L_end
L_eok:
    ds_write_b128 v70, v[184:187] offset:0
    ds_write_b32 v54, v188 offset:1024
    s_lshl_b32 s11, s5, 4
    v_lshl_add_u32 v6, v1, 7, s11
    v_lshrrev_b32 v7, 2, v1
    v_lshl_add_u32 v7, v7, 7, s11
    v_lshl_add_u32 v7, v53, 2, v7
    s_waitcnt lgkmcnt(0)
    s_barrier
    ds_read_b128 v[184:187], v6 offset:0
    ds_read_b32 v188, v7 offset:8192
    s_cmp_eq_u32 s83, 0
    s_cbranch_scc1 L_noyt
    global_atomic_or_x2 v[224:225], v55, v[62:63], s[52:53] sc0 sc1
    global_atomic_or_x2 v[226:227], v69, v[62:63], s[52:53] sc0 sc1
L_noyt:
    s_waitcnt lgkmcnt(0)
    v_lshlrev_b32 v200, 16, v184
    v_and_b32 v201, 0xffff0000, v184
    v_lshlrev_b32 v202, 16, v185
    v_and_b32 v203, 0xffff0000, v185
    v_lshlrev_b32 v204, 16, v186
    v_and_b32 v205, 0xffff0000, v186
    v_lshlrev_b32 v206, 16, v187
    v_and_b32 v207, 0xffff0000, v187
    v_lshlrev_b32 v208, 16, v188
    v_and_b32 v209, 0xffff0000, v188
    v_readfirstlane_b32 s10, v200
    s_nop 1
    v_subrev_f32 v212, s10, v200
    v_subrev_f32 v213, s10, v201
    v_subrev_f32 v214, s10, v202
    v_subrev_f32 v215, s10, v203
    v_subrev_f32 v216, s10, v204
    v_subrev_f32 v217, s10, v205
    v_subrev_f32 v218, s10, v206
    v_subrev_f32 v219, s10, v207
    v_subrev_f32 v220, s10, v208
    v_subrev_f32 v221, s10, v209
    v_add_f32 v192, v212, v213
    v_mul_f32 v193, v212, v212
    v_add_f32 v194, v214, v215
    v_mul_f32 v195, v213, v213
    v_fmac_f32 v193, v214, v214
    v_fmac_f32 v195, v215, v215
    v_fmac_f32 v193, v216, v216
    v_fmac_f32 v195, v217, v217
    v_add_f32 v192, v192, v216
    v_add_f32 v194, v194, v217
    v_fmac_f32 v193, v218, v218
    v_fmac_f32 v195, v219, v219
    v_add_f32 v192, v192, v218
    v_add_f32 v194, v194, v219
    v_fmac_f32 v193, v220, v220
    v_fmac_f32 v195, v221, v221
    v_add_f32 v192, v192, v220
    v_add_f32 v194, v194, v221
    v_add_f32 v192, v192, v194
    v_add_f32 v193, v193, v195
    s_nop 1
    v_permlane32_swap_b32 v192, v193
    v_add_f32 v192, v192, v193
    s_nop 1
    v_add_f32_dpp v192, v192, v192 quad_perm:[1,0,3,2] row_mask:0xf bank_mask:0xf
    s_nop 1
    v_add_f32_dpp v192, v192, v192 quad_perm:[2,3,0,1] row_mask:0xf bank_mask:0xf
    s_nop 1
    v_add_f32_dpp v192, v192, v192 row_half_mirror row_mask:0xf bank_mask:0xf
    s_nop 1
    v_add_f32_dpp v192, v192, v192 row_mirror row_mask:0xf bank_mask:0xf
    s_nop 1
    v_add_f32_dpp v192, v192, v192 row_bcast:15 row_mask:0xa bank_mask:0xf
    v_mul_f32 v192, 0x3acccccd, v192
    s_nop 0
    v_readlane_b32 s11, v192, 31
    v_readlane_b32 s12, v192, 63
    s_nop 0
    v_mov_b32 v193, s11
    v_add_f32 v192, s10, v193
    v_fma_f32 v193, -v193, v193, s12
    v_max_f32 v193, 0, v193
    v_cvt_pk_bf16_f32 v194, v192, v193
    v_lshlrev_b32 v192, 16, v194
    v_and_b32 v193, 0xffff0000, v194
    v_add_f32 v193, 0x3727c5ac, v193
    v_cvt_pk_bf16_f32 v193, v193, v193
    v_and_b32 v193, 0xffff0000, v193
    v_sqrt_f32 v193, v193
    v_sub_f32 v212, v200, v192
    v_sub_f32 v213, v201, v192
    v_sub_f32 v214, v202, v192
    v_sub_f32 v215, v203, v192
    v_sub_f32 v216, v204, v192
    v_sub_f32 v217, v205, v192
    v_sub_f32 v218, v206, v192
    v_sub_f32 v219, v207, v192
    v_sub_f32 v220, v208, v192
    v_sub_f32 v221, v209, v192
    v_cvt_pk_bf16_f32 v193, v193, v193
    v_and_b32 v193, 0xffff0000, v193
    v_rcp_f32 v196, v193
    v_mov_b32 v210, v192
    v_mov_b32 v211, v196
    v_cvt_pk_bf16_f32 v194, v212, v213
    v_lshlrev_b32 v212, 16, v194
    v_and_b32 v213, 0xffff0000, v194
    v_cvt_pk_bf16_f32 v195, v214, v215
    v_lshlrev_b32 v214, 16, v195
    v_and_b32 v215, 0xffff0000, v195
    v_cvt_pk_bf16_f32 v194, v216, v217
    v_lshlrev_b32 v216, 16, v194
    v_and_b32 v217, 0xffff0000, v194
    v_cvt_pk_bf16_f32 v195, v218, v219
    v_lshlrev_b32 v218, 16, v195
    v_and_b32 v219, 0xffff0000, v195
    v_cvt_pk_bf16_f32 v194, v220, v221
    v_lshlrev_b32 v220, 16, v194
    v_and_b32 v221, 0xffff0000, v194
    v_mul_f32 v212, v212, v196
    v_mul_f32 v213, v213, v196
    v_mul_f32 v214, v214, v196
    v_mul_f32 v215, v215, v196
    v_mul_f32 v216, v216, v196
    v_mul_f32 v217, v217, v196
    v_mul_f32 v218, v218, v196
    v_mul_f32 v219, v219, v196
    v_mul_f32 v220, v220, v196
    v_mul_f32 v221, v221, v196
    v_cvt_pk_bf16_f32 v192, v212, v213
    v_cvt_pk_bf16_f32 v193, v214, v215
    v_cvt_pk_bf16_f32 v194, v216, v217
    v_cvt_pk_bf16_f32 v195, v218, v219
    v_cvt_pk_bf16_f32 v196, v220, v221
    v_lshlrev_b32 v200, 16, v192
    v_and_b32 v201, 0xffff0000, v192
    v_lshlrev_b32 v212, 16, v64
    v_and_b32 v213, 0xffff0000, v64
    v_lshlrev_b32 v202, 16, v193
    v_and_b32 v203, 0xffff0000, v193
    v_lshlrev_b32 v214, 16, v65
    v_and_b32 v215, 0xffff0000, v65
    v_lshlrev_b32 v204, 16, v194
    v_and_b32 v205, 0xffff0000, v194
    v_lshlrev_b32 v216, 16, v66
    v_and_b32 v217, 0xffff0000, v66
    v_lshlrev_b32 v206, 16, v195
    v_and_b32 v207, 0xffff0000, v195
    v_lshlrev_b32 v218, 16, v67
    v_and_b32 v219, 0xffff0000, v67
    v_lshlrev_b32 v208, 16, v196
    v_and_b32 v209, 0xffff0000, v196
    v_lshlrev_b32 v220, 16, v68
    v_and_b32 v221, 0xffff0000, v68
    v_mul_f32 v6, v200, v212
    v_fmac_f32 v6, v201, v213
    v_fmac_f32 v6, v202, v214
    v_fmac_f32 v6, v203, v215
    v_fmac_f32 v6, v204, v216
    v_fmac_f32 v6, v205, v217
    v_fmac_f32 v6, v206, v218
    v_fmac_f32 v6, v207, v219
    v_fmac_f32 v6, v208, v220
    v_fmac_f32 v6, v209, v221
    s_nop 1
    v_add_f32_dpp v6, v6, v6 quad_perm:[1,0,3,2] row_mask:0xf bank_mask:0xf
    s_nop 1
    v_add_f32_dpp v6, v6, v6 quad_perm:[2,3,0,1] row_mask:0xf bank_mask:0xf
    s_nop 1
    v_add_f32_dpp v6, v6, v6 row_ror:8 row_mask:0xf bank_mask:0xf
    s_nop 1
    v_add_f32_dpp v6, v6, v6 row_ror:4 row_mask:0xf bank_mask:0xf
    v_mov_b32 v200, v6
    s_nop 1
    v_permlane16_swap_b32 v6, v200
    v_add_f32 v6, v6, v200
    v_mov_b32 v200, v6
    s_nop 1
    v_permlane32_swap_b32 v6, v200
    v_add_f32 v6, v6, v200
    v_cvt_pk_bf16_f32 v6, v6, v6
    v_and_b32 v6, 0xffff0000, v6
    v_mul_f32 v6, 0xbfb8aa3b, v6
    v_exp_f32 v6, v6
    s_nop 0
    v_add_f32 v6, 1.0, v6
    v_rcp_f32 v6, v6
    s_nop 0
    v_cvt_pk_bf16_f32 v6, v6, v6
    v_and_b32 v6, 0xffff0000, v6
    v_mov_b32 v208, v6
    s_lshl_b32 s11, s5, 4
    v_mov_b32 v7, s11
    ds_write_b128 v7, v[208:211] offset:25088
    s_cmp_eq_u32 s83, 0
    s_waitcnt lgkmcnt(0)
    s_barrier
    s_cbranch_scc1 L_fin
    ds_read_b128 v[200:203], v57 offset:25088
    ds_read_u16 v180, v58 offset:0
    s_waitcnt lgkmcnt(0)
    v_lshlrev_b32 v180, 16, v180
    v_sub_f32 v212, v180, v202
    v_cvt_pk_bf16_f32 v212, v212, v212
    v_and_b32 v212, 0xffff0000, v212
    v_mul_f32 v212, v212, v203
    v_cvt_pk_bf16_f32 v212, v212, v212
    v_and_b32 v212, 0xffff0000, v212
    v_lshlrev_b32 v6, 3, v53
    v_lshrrev_b32 v6, v6, s76
    v_and_b32 v214, 15, v6
    v_bfe_u32 v215, v6, 4, 4
    global_atomic_or_x2 v[224:225], v55, v[62:63], s[52:53] sc0 sc1
    global_atomic_or_x2 v[226:227], v69, v[62:63], s[52:53] sc0 sc1
    s_sleep 4
    global_atomic_or_x2 v[228:229], v55, v[62:63], s[52:53] sc0 sc1
    global_atomic_or_x2 v[230:231], v69, v[62:63], s[52:53] sc0 sc1
    s_sleep 4
L_ypipe:
    global_atomic_or_x2 v[232:233], v55, v[62:63], s[52:53] sc0 sc1
    global_atomic_or_x2 v[234:235], v69, v[62:63], s[52:53] sc0 sc1
    s_waitcnt vmcnt(4)
    v_xor_b32 v160, v214, v224
    v_xor_b32 v161, v215, v225
    v_xor_b32 v162, v214, v226
    v_xor_b32 v163, v215, v227
    v_or3_b32 v6, v160, v161, v162
    v_or_b32 v6, v6, v163
    v_and_b32 v6, 15, v6
    v_cmp_ne_u32 vcc, 0, v6
    s_nop 0
    s_cbranch_vccz L_yok
    s_sleep 3
    global_atomic_or_x2 v[224:225], v55, v[62:63], s[52:53] sc0 sc1
    global_atomic_or_x2 v[226:227], v69, v[62:63], s[52:53] sc0 sc1
    s_waitcnt vmcnt(4)
    v_xor_b32 v160, v214, v228
    v_xor_b32 v161, v215, v229
    v_xor_b32 v162, v214, v230
    v_xor_b32 v163, v215, v231
    v_or3_b32 v6, v160, v161, v162
    v_or_b32 v6, v6, v163
    v_and_b32 v6, 15, v6
    v_cmp_ne_u32 vcc, 0, v6
    s_nop 0
    s_cbranch_vccz L_yok
    s_sleep 3
    global_atomic_or_x2 v[228:229], v55, v[62:63], s[52:53] sc0 sc1
    global_atomic_or_x2 v[230:231], v69, v[62:63], s[52:53] sc0 sc1
    s_waitcnt vmcnt(4)
    v_xor_b32 v160, v214, v232
    v_xor_b32 v161, v215, v233
    v_xor_b32 v162, v214, v234
    v_xor_b32 v163, v215, v235
    v_or3_b32 v6, v160, v161, v162
    v_or_b32 v6, v6, v163
    v_and_b32 v6, 15, v6
    v_cmp_ne_u32 vcc, 0, v6
    s_nop 0
    s_cbranch_vccz L_yok
    s_sleep 3
    s_sub_u32 s9, s9, 1
    s_cbranch_scc0 L_ypipe
    s_branch L_end
L_yok:
    v_pk_add_f32 v[160:161], v[160:161], v[162:163]
    s_nop 1
    v_permlane32_swap_b32 v160, v161
    v_add_f32 v162, v160, v161
    v_add_f32 v160, v160, v161
    s_nop 1
    v_permlane16_swap_b32 v160, v162
    v_add_f32 v160, v160, v162
    v_cvt_pk_bf16_f32 v160, v160, v160
    v_and_b32 v160, 0xffff0000, v160
    v_mul_f32 v160, v160, v200
    v_cvt_pk_bf16_f32 v160, v160, v160
    v_and_b32 v160, 0xffff0000, v160
    v_add_f32 v160, v160, v212
    v_cvt_pk_bf16_f32 v160, v160, v160
    v_and_b32 v160, 0xffff0000, v160
    v_add_f32 v161, v160, v180
    v_add_f32 v160, v160, v180
    s_nop 1
    v_permlane32_swap_b32 v160, v161
    s_mov_b64 exec, 0xffff
    v_cvt_pk_bf16_f32 v160, v160, v161
    global_store_dword v56, v160, s[36:37]
    s_branch L_fin
L_ffn:
    s_cmp_eq_u32 s6, 0
    s_cbranch_scc1 L_fin
    s_cmp_eq_u32 s6, 2
    s_barrier
    s_cbranch_scc1 L_down
    buffer_load_dwordx4 v[144:147], v44, s[60:63], s71 offen sc1
    buffer_load_dword v148, v61, s[60:63], s71 offen offset:1024 sc1
    v_mov_b32 v192, 0x3f803f80
    v_mov_b32 v193, 0x3f803f80
    v_mov_b32 v194, 0x3f803f80
    v_mov_b32 v195, 0x3f803f80
    s_mov_b32 m0, s23
    s_add_u32 s23, s23, 1024
    buffer_load_dwordx4 v4, s[56:59], s8 offen  lds
    s_add_u32 s8, s8, s43
    s_mov_b32 m0, s23
    s_add_u32 s23, s23, 1024
    buffer_load_dwordx4 v4, s[56:59], s8 offen  lds
    s_add_u32 s8, s8, s43
    s_mov_b32 m0, s23
    s_add_u32 s23, s23, 1024
    buffer_load_dwordx4 v4, s[56:59], s8 offen  lds
    s_add_u32 s8, s8, s43
    s_mov_b32 s8, s86
    s_mov_b32 s23, s87
    s_mov_b32 m0, s23
    s_add_u32 s23, s23, 1024
    buffer_load_dwordx4 v4, s[56:59], s8 offen  lds
    s_add_u32 s8, s8, s43
    s_mov_b32 m0, s23
    s_add_u32 s23, s23, 1024
    buffer_load_dwordx4 v4, s[56:59], s8 offen  lds
    s_add_u32 s8, s8, s43
    s_mov_b32 m0, s23
    s_add_u32 s23, s23, 1024
    buffer_load_dwordx4 v4, s[56:59], s8 offen  lds
    s_add_u32 s8, s8, s43
    s_mov_b32 m0, s23
    s_add_u32 s23, s23, 1024
    buffer_load_dwordx4 v4, s[56:59], s8 offen  lds
    s_add_u32 s8, s8, s43
    s_mov_b32 m0, s23
    s_add_u32 s23, s23, 1024
    buffer_load_dwordx4 v4, s[56:59], s8 offen  lds
    s_add_u32 s8, s8, s43
    s_waitcnt vmcnt(0)
    ds_read_b64_tr_b16 v[72:73], v58 offset:0
    ds_read_b64_tr_b16 v[74:75], v58 offset:256
    ds_read_b64_tr_b16 v[92:93], v60 offset:0
    ds_read_b64_tr_b16 v[94:95], v60 offset:256
    ds_read_b64_tr_b16 v[76:77], v58 offset:2048
    ds_read_b64_tr_b16 v[78:79], v58 offset:2304
    ds_read_b64_tr_b16 v[96:97], v60 offset:2048
    ds_read_b64_tr_b16 v[98:99], v60 offset:2304
    ds_read_b64_tr_b16 v[80:81], v58 offset:4096
    ds_read_b64_tr_b16 v[82:83], v58 offset:4352
    ds_read_b64_tr_b16 v[100:101], v60 offset:4096
    ds_read_b64_tr_b16 v[102:103], v60 offset:4352
    s_waitcnt lgkmcnt(8)
    v_mfma_f32_16x16x32_bf16 v[20:23], v[72:75], v[192:195], 0
    v_mfma_f32_16x16x32_bf16 v[24:27], v[92:95], v[192:195], 0
    ds_read_b64_tr_b16 v[84:85], v58 offset:6144
    ds_read_b64_tr_b16 v[86:87], v58 offset:6400
    ds_read_b64_tr_b16 v[104:105], v60 offset:6144
    ds_read_b64_tr_b16 v[106:107], v60 offset:6400
    s_waitcnt lgkmcnt(8)
    v_mfma_f32_16x16x32_bf16 v[20:23], v[76:79], v[192:195], v[20:23]
    v_mfma_f32_16x16x32_bf16 v[24:27], v[96:99], v[192:195], v[24:27]
    ds_read_b64_tr_b16 v[88:89], v58 offset:8192
    ds_read_b64_tr_b16 v[90:91], v58 offset:8448
    ds_read_b64_tr_b16 v[108:109], v60 offset:8192
    ds_read_b64_tr_b16 v[110:111], v60 offset:8448
    s_waitcnt lgkmcnt(8)
    v_mfma_f32_16x16x32_bf16 v[20:23], v[80:83], v[192:195], v[20:23]
    v_mfma_f32_16x16x32_bf16 v[24:27], v[100:103], v[192:195], v[24:27]
    buffer_load_dwordx4 v[160:163], v55, s[60:63], s69 offen offset:0 sc1
    buffer_load_dwordx4 v[164:167], v55, s[60:63], s69 offen offset:1024 sc1
    buffer_load_dwordx4 v[168:171], v53, s[60:63], s69 offen offset:2048 sc1
    s_waitcnt lgkmcnt(4)
    v_mfma_f32_16x16x32_bf16 v[20:23], v[84:87], v[192:195], v[20:23]
    v_mfma_f32_16x16x32_bf16 v[24:27], v[104:107], v[192:195], v[24:27]
    s_waitcnt lgkmcnt(0)
    v_mfma_f32_16x16x32_bf16 v[20:23], v[88:91], v[192:195], v[20:23]
    v_mfma_f32_16x16x32_bf16 v[24:27], v[108:111], v[192:195], v[24:27]
    s_nop 7
    v_mov_b32_dpp v20, v24 quad_perm:[0,1,2,3] row_mask:0xf bank_mask:0xc
    v_mov_b32_dpp v21, v25 quad_perm:[0,1,2,3] row_mask:0xf bank_mask:0xc
    v_mov_b32_dpp v22, v26 quad_perm:[0,1,2,3] row_mask:0xf bank_mask:0xc
    v_mov_b32_dpp v23, v27 quad_perm:[0,1,2,3] row_mask:0xf bank_mask:0xc
    ds_write_b128 v56, v[20:23] offset:10496
    s_cmp_lt_u32 s5, 4
    s_cbranch_scc1 L_h0c0
    s_branch L_h1c0
L_h0r0:
    s_sub_u32 s9, s9, 1
    s_cbranch_scc1 L_end
    buffer_load_dwordx4 v[160:163], v55, s[60:63], s69 offen offset:0 sc1
    buffer_load_dwordx4 v[164:167], v55, s[60:63], s69 offen offset:1024 sc1
    buffer_load_dwordx4 v[168:171], v53, s[60:63], s69 offen offset:2048 sc1
    s_branch L_h0c0
L_h0r1:
    s_sub_u32 s9, s9, 1
    s_cbranch_scc1 L_end
    buffer_load_dwordx4 v[164:167], v55, s[60:63], s69 offen offset:1024 sc1
    buffer_load_dwordx4 v[168:171], v53, s[60:63], s69 offen offset:2048 sc1
    s_branch L_h0c1
L_h0r2:
    s_sub_u32 s9, s9, 1
    s_cbranch_scc1 L_end
    buffer_load_dwordx4 v[168:171], v53, s[60:63], s69 offen offset:2048 sc1
    s_branch L_h0c2
L_h1r0:
    s_sub_u32 s9, s9, 1
    s_cbranch_scc1 L_end
    buffer_load_dwordx4 v[160:163], v55, s[60:63], s69 offen offset:0 sc1
    buffer_load_dwordx4 v[164:167], v55, s[60:63], s69 offen offset:1024 sc1
    buffer_load_dwordx4 v[168:171], v53, s[60:63], s69 offen offset:2048 sc1
    s_branch L_h1c0
L_h1r1:
    s_sub_u32 s9, s9, 1
    s_cbranch_scc1 L_end
    buffer_load_dwordx4 v[164:167], v55, s[60:63], s69 offen offset:1024 sc1
    buffer_load_dwordx4 v[168:171], v53, s[60:63], s69 offen offset:2048 sc1
    s_branch L_h1c1
L_h1r2:
    s_sub_u32 s9, s9, 1
    s_cbranch_scc1 L_end
    buffer_load_dwordx4 v[168:171], v53, s[60:63], s69 offen offset:2048 sc1
    s_branch L_h1c2
L_h1c0:
    s_waitcnt vmcnt(2)
    v_max3_u32 v6, v160, v161, v162
    v_max_u32 v6, v6, v163
    v_cmp_eq_u32 vcc, -1, v6
    s_nop 0
    s_cbranch_vccnz L_h1r0
    v_mfma_f32_16x16x32_bf16 v[176:179], v[72:75], v[160:163], 0
    v_dot2_f32_bf16 v24, v160, v160, 0
    v_dot2_f32_bf16 v25, v161, v161, 0
    v_mfma_f32_16x16x32_bf16 v[184:187], v[92:95], v[160:163], 0
    v_dot2_f32_bf16 v24, v162, v162, v24
    v_dot2_f32_bf16 v25, v163, v163, v25
    v_mfma_f32_16x16x32_bf16 v[180:183], v[76:79], v[160:163], 0
    v_mfma_f32_16x16x32_bf16 v[188:191], v[96:99], v[160:163], 0
L_h1c1:
    s_waitcnt vmcnt(1)
    v_max3_u32 v6, v164, v165, v166
    v_max_u32 v6, v6, v167
    v_cmp_eq_u32 vcc, -1, v6
    s_nop 0
    s_cbranch_vccnz L_h1r1
    v_mfma_f32_16x16x32_bf16 v[176:179], v[80:83], v[164:167], v[176:179]
    v_dot2_f32_bf16 v24, v164, v164, v24
    v_dot2_f32_bf16 v25, v165, v165, v25
    v_mfma_f32_16x16x32_bf16 v[184:187], v[100:103], v[164:167], v[184:187]
    v_dot2_f32_bf16 v24, v166, v166, v24
    v_dot2_f32_bf16 v25, v167, v167, v25
    v_mfma_f32_16x16x32_bf16 v[180:183], v[84:87], v[164:167], v[180:183]
    v_mfma_f32_16x16x32_bf16 v[188:191], v[104:107], v[164:167], v[188:191]
L_h1c2:
    s_waitcnt vmcnt(0)
    v_max3_u32 v6, v168, v169, v170
    v_max_u32 v6, v6, v171
    v_cmp_eq_u32 vcc, -1, v6
    s_nop 0
    s_cbranch_vccnz L_h1r2
    v_dot2_f32_bf16 v24, v168, v168, v24
    v_dot2_f32_bf16 v25, v169, v169, v25
    v_dot2_f32_bf16 v24, v170, v170, v24
    v_dot2_f32_bf16 v25, v171, v171, v25
    v_mfma_f32_16x16x32_bf16 v[176:179], v[88:91], v[168:171], v[176:179]
    v_mfma_f32_16x16x32_bf16 v[184:187], v[108:111], v[168:171], v[184:187]
    s_nop 0
    v_add_f32 v24, v24, v25
    s_nop 1
    v_add_f32_dpp v24, v24, v24 row_ror:8 row_mask:0xf bank_mask:0xf
    v_mov_b32 v25, v24
    s_nop 1
    v_permlane16_swap_b32 v24, v25
    v_add_f32 v24, v24, v25
    v_mov_b32 v25, v24
    s_nop 1
    v_permlane32_swap_b32 v24, v25
    v_add_f32 v24, v24, v25
    s_branch L_cjoin
L_h0c0:
    s_waitcnt vmcnt(2)
    v_max3_u32 v6, v160, v161, v162
    v_max_u32 v6, v6, v163
    v_cmp_eq_u32 vcc, -1, v6
    s_nop 0
    s_cbranch_vccnz L_h0r0
    v_mfma_f32_16x16x32_bf16 v[176:179], v[72:75], v[160:163], 0
    v_dot2_f32_bf16 v24, v160, v192, 0
    v_dot2_f32_bf16 v25, v161, v192, 0
    v_mfma_f32_16x16x32_bf16 v[184:187], v[92:95], v[160:163], 0
    v_dot2_f32_bf16 v24, v162, v192, v24
    v_dot2_f32_bf16 v25, v163, v192, v25
    v_mfma_f32_16x16x32_bf16 v[180:183], v[76:79], v[160:163], 0
    v_mfma_f32_16x16x32_bf16 v[188:191], v[96:99], v[160:163], 0
L_h0c1:
    s_waitcnt vmcnt(1)
    v_max3_u32 v6, v164, v165, v166
    v_max_u32 v6, v6, v167
    v_cmp_eq_u32 vcc, -1, v6
    s_nop 0
    s_cbranch_vccnz L_h0r1
    v_mfma_f32_16x16x32_bf16 v[176:179], v[80:83], v[164:167], v[176:179]
    v_dot2_f32_bf16 v24, v164, v192, v24
    v_dot2_f32_bf16 v25, v165, v192, v25
    v_mfma_f32_16x16x32_bf16 v[184:187], v[100:103], v[164:167], v[184:187]
    v_dot2_f32_bf16 v24, v166, v192, v24
    v_dot2_f32_bf16 v25, v167, v192, v25
    v_mfma_f32_16x16x32_bf16 v[180:183], v[84:87], v[164:167], v[180:183]
    v_mfma_f32_16x16x32_bf16 v[188:191], v[104:107], v[164:167], v[188:191]
L_h0c2:
    s_waitcnt vmcnt(0)
    v_max3_u32 v6, v168, v169, v170
    v_max_u32 v6, v6, v171
    v_cmp_eq_u32 vcc, -1, v6
    s_nop 0
    s_cbranch_vccnz L_h0r2
    v_dot2_f32_bf16 v24, v168, v192, v24
    v_dot2_f32_bf16 v25, v169, v192, v25
    v_dot2_f32_bf16 v24, v170, v192, v24
    v_dot2_f32_bf16 v25, v171, v192, v25
    v_mfma_f32_16x16x32_bf16 v[176:179], v[88:91], v[168:171], v[176:179]
    v_mfma_f32_16x16x32_bf16 v[184:187], v[108:111], v[168:171], v[184:187]
    s_nop 0
    v_add_f32 v24, v24, v25
    s_nop 1
    v_add_f32_dpp v24, v24, v24 row_ror:8 row_mask:0xf bank_mask:0xf
    v_mov_b32 v25, v24
    s_nop 1
    v_permlane16_swap_b32 v24, v25
    v_add_f32 v24, v24, v25
    v_mov_b32 v25, v24
    s_nop 1
    v_permlane32_swap_b32 v24, v25
    v_add_f32 v24, v24, v25
L_cjoin:
    ds_write_b32 v51, v24 offset:0
    s_cmp_lt_u32 s5, 4
    v_add_f32_dpp v20, v180, v176 row_ror:8 row_mask:0xf bank_mask:0x3
    v_add_f32_dpp v21, v181, v177 row_ror:8 row_mask:0xf bank_mask:0x3
    v_add_f32_dpp v22, v182, v178 row_ror:8 row_mask:0xf bank_mask:0x3
    v_add_f32_dpp v23, v183, v179 row_ror:8 row_mask:0xf bank_mask:0x3
    v_add_f32_dpp v20, v184, v188 row_ror:8 row_mask:0xf bank_mask:0xc
    v_add_f32_dpp v21, v185, v189 row_ror:8 row_mask:0xf bank_mask:0xc
    v_add_f32_dpp v22, v186, v190 row_ror:8 row_mask:0xf bank_mask:0xc
    v_add_f32_dpp v23, v187, v191 row_ror:8 row_mask:0xf bank_mask:0xc
    ds_write_b128 v56, v[20:23] offset:25088
    s_waitcnt lgkmcnt(0)
    s_barrier
    s_cbranch_scc0 L_fin
    ds_read_b128 v[160:163], v52 offset:0
    ds_read_b128 v[164:167], v52 offset:128
    ds_read_b64 v[192:193], v57 offset:25088
    ds_read_b64 v[194:195], v57 offset:26144
    ds_read_b64 v[196:197], v57 offset:27200
    ds_read_b64 v[198:199], v57 offset:28256
    ds_read_b64 v[224:225], v57 offset:10496
    ds_read_b64 v[226:227], v57 offset:11552
    ds_read_b64 v[228:229], v57 offset:12608
    ds_read_b64 v[230:231], v57 offset:13664
    s_cmp_eq_u32 s1, 1
    s_waitcnt lgkmcnt(8)
    v_pk_add_f32 v[160:161], v[160:161], v[162:163]
    v_pk_add_f32 v[164:165], v[164:165], v[166:167]
    v_add_f32 v200, v160, v161
    v_add_f32 v201, v164, v165
    v_mul_f32 v200, 0x3acccccd, v200
    v_mul_f32 v201, 0x3acccccd, v201
    v_fma_f32 v201, -v200, v200, v201
    v_max_f32 v201, 0, v201
    v_cvt_pk_bf16_f32 v160, v200, v201
    v_and_b32 v201, 0xffff0000, v160
    v_add_f32 v201, 0x3727c5ac, v201
    v_cvt_pk_bf16_f32 v201, v201, v201
    v_and_b32 v201, 0xffff0000, v201
    v_sqrt_f32 v201, v201
    v_lshlrev_b32 v200, 16, v160
    s_waitcnt lgkmcnt(0)
    v_cvt_pk_bf16_f32 v201, v201, v201
    v_and_b32 v201, 0xffff0000, v201
    v_rcp_f32 v201, v201
    v_pk_add_f32 v[224:225], v[224:225], v[226:227]
    v_pk_add_f32 v[228:229], v[228:229], v[230:231]
    v_pk_add_f32 v[224:225], v[224:225], v[228:229]
    v_pk_add_f32 v[192:193], v[192:193], v[194:195]
    v_pk_add_f32 v[196:197], v[196:197], v[198:199]
    v_pk_add_f32 v[192:193], v[192:193], v[196:197]
    v_fma_f32 v192, -v200, v224, v192
    v_fma_f32 v193, -v200, v225, v193
    v_mul_f32 v192, v192, v201
    v_mul_f32 v193, v193, v201
    v_mul_f32 v196, 0xbfb8aa3b, v192
    v_mul_f32 v197, 0xbfb8aa3b, v193
    v_exp_f32 v196, v196
    v_exp_f32 v197, v197
    v_mul_f32_dpp v194, v192, v192 row_ror:8 row_mask:0xf bank_mask:0xf
    v_mul_f32_dpp v195, v193, v193 row_ror:8 row_mask:0xf bank_mask:0xf
    v_add_f32 v196, 1.0, v196
    v_add_f32 v197, 1.0, v197
    v_rcp_f32 v196, v196
    v_rcp_f32 v197, v197
    s_mov_b32 exec_lo, 0x00ff00ff
    s_mov_b32 exec_hi, 0x00ff00ff
    v_mul_f32 v196, v196, v194
    v_mul_f32 v197, v197, v195
    v_cvt_pk_bf16_f32 v192, v196, v197
    v_min_u32 v192, -2, v192
    s_cbranch_scc0 L_ls5
    buffer_store_dword v192, v59, s[64:67], s70 offen
L_le5:
    s_branch L_fin
L_down:
    s_cmp_lt_u32 s7, 4
    s_cbranch_scc0 L_nodh
    s_mov_b32 exec_hi, 0
    global_load_dword v45, v69, s[84:85]
    s_mov_b64 exec, -1
    s_branch L_nouh
L_nodh:
    s_and_b32 s10, s2, 7
    s_mul_i32 s11, s10, 448
    s_bitcmp0_b32 s10, 0
    s_cselect_b32 s12, 384, 0
    s_cselect_b32 s13, 276480, 0
    s_add_u32 s11, s11, s12
    s_and_b32 s11, s11, -128
    s_add_u32 s11, s11, s13
    s_and_b32 s12, s5, 3
    s_mul_i32 s12, s12, 552960
    s_add_u32 s11, s11, s12
    s_cmp_lt_u32 s5, 4
    s_cselect_b32 s84, s30, s32
    s_cselect_b32 s85, s31, s33
    s_add_u32 s84, s84, s11
    s_addc_u32 s85, s85, 0
    v_mul_u32_u24 v6, 3456, v1
    s_mov_b32 exec_hi, -1
    global_load_dword v45, v6, s[84:85]
    s_mov_b64 exec, -1
L_nouh:
    s_mov_b32 m0, s23
    s_add_u32 s23, s23, 1024
    buffer_load_dwordx4 v4, s[56:59], s8 offen nt lds
    s_add_u32 s8, s8, s43
    s_mov_b32 m0, s23
    s_add_u32 s23, s23, 1024
    buffer_load_dwordx4 v4, s[56:59], s8 offen nt lds
    s_add_u32 s8, s8, s43
    s_mov_b32 m0, s23
    s_add_u32 s23, s23, 1024
    buffer_load_dwordx4 v4, s[56:59], s8 offen nt lds
    s_add_u32 s8, s8, s43
    s_mov_b32 m0, s23
    s_add_u32 s23, s23, 1024
    buffer_load_dwordx4 v4, s[56:59], s8 offen nt lds
    s_add_u32 s8, s8, s43
    s_mov_b32 m0, s23
    s_add_u32 s23, s23, 1024
    buffer_load_dwordx4 v4, s[56:59], s8 offen nt lds
    s_add_u32 s8, s8, s43
    s_mov_b32 m0, s23
    s_add_u32 s23, s23, 1024
    buffer_load_dwordx4 v4, s[56:59], s8 offen nt lds
    s_add_u32 s8, s8, s43
    s_mov_b32 m0, s23
    s_add_u32 s23, s23, 1024
    buffer_load_dwordx4 v4, s[56:59], s8 offen nt lds
    s_add_u32 s8, s8, s43
    s_cmp_lt_u32 s5, 4
    s_waitcnt vmcnt(0)
    s_barrier
    s_cbranch_scc0 L_fin
    ds_read_b64_tr_b16 v[72:73], v52 offset:0
    ds_read_b64_tr_b16 v[74:75], v57 offset:8192
    ds_read_b64_tr_b16 v[76:77], v52 offset:1024
    ds_read_b64_tr_b16 v[78:79], v57 offset:9216
    ds_read_b64_tr_b16 v[80:81], v52 offset:2048
    ds_read_b64_tr_b16 v[82:83], v57 offset:10240
    ds_read_b64_tr_b16 v[84:85], v52 offset:3072
    ds_read_b64_tr_b16 v[86:87], v57 offset:11264
    s_waitcnt lgkmcnt(4)
    ds_read_b64_tr_b16 v[88:89], v52 offset:4096
    ds_read_b64_tr_b16 v[90:91], v57 offset:12288
    ds_read_b64_tr_b16 v[92:93], v52 offset:5120
    ds_read_b64_tr_b16 v[94:95], v57 offset:13312
    ds_read_b64_tr_b16 v[96:97], v52 offset:6144
    ds_read_b64_tr_b16 v[98:99], v57 offset:14336
    ds_read_b64_tr_b16 v[100:101], v53 offset:0
    ds_read_b64_tr_b16 v[102:103], v58 offset:8192
    s_waitcnt lgkmcnt(4)
    ds_read_b64_tr_b16 v[104:105], v53 offset:1024
    ds_read_b64_tr_b16 v[106:107], v58 offset:9216
    ds_read_b64_tr_b16 v[108:109], v53 offset:2048
    ds_read_b64_tr_b16 v[110:111], v58 offset:10240
    ds_read_b64_tr_b16 v[112:113], v53 offset:3072
    ds_read_b64_tr_b16 v[114:115], v58 offset:11264
    ds_read_b64_tr_b16 v[116:117], v53 offset:4096
    ds_read_b64_tr_b16 v[118:119], v58 offset:12288
    s_waitcnt lgkmcnt(4)
    ds_read_b64_tr_b16 v[120:121], v53 offset:5120
    ds_read_b64_tr_b16 v[122:123], v58 offset:13312
    ds_read_b64_tr_b16 v[124:125], v53 offset:6144
    ds_read_b64_tr_b16 v[126:127], v58 offset:14336
L_apoll:
    s_sub_u32 s9, s9, 1
    s_cbranch_scc1 L_end
    buffer_load_dwordx4 v[128:131], v51, s[64:67], 0 offen offset:0 sc1
    buffer_load_dwordx4 v[132:135], v51, s[64:67], 0 offen offset:1024 sc1
    buffer_load_dwordx4 v[136:139], v51, s[64:67], 0 offen offset:2048 sc1
    buffer_load_dwordx4 v[140:143], v51, s[64:67], 0 offen offset:3072 sc1
    s_waitcnt vmcnt(3) lgkmcnt(0)
    v_max3_u32 v6, v128, v129, v130
    v_max_u32 v6, v6, v131
    s_waitcnt vmcnt(2)
    v_max3_u32 v6, v6, v132, v133
    v_max3_u32 v6, v6, v134, v135
    s_waitcnt vmcnt(1)
    v_max3_u32 v6, v6, v136, v137
    v_max3_u32 v6, v6, v138, v139
    s_waitcnt vmcnt(0)
    v_max3_u32 v6, v6, v140, v141
    v_max3_u32 v6, v6, v142, v143
    v_cmp_eq_u32 vcc, -1, v6
    s_nop 0
    s_cbranch_vccnz L_apoll
    v_mfma_f32_16x16x32_bf16 v[148:151], v[76:79], v[128:131], 0
    v_mfma_f32_16x16x32_bf16 v[156:159], v[104:107], v[128:131], 0
    v_mfma_f32_16x16x32_bf16 v[144:147], v[72:75], v[128:131], 0
    v_mfma_f32_16x16x32_bf16 v[152:155], v[100:103], v[128:131], 0
    v_mfma_f32_16x16x32_bf16 v[148:151], v[84:87], v[132:135], v[148:151]
    v_mfma_f32_16x16x32_bf16 v[156:159], v[112:115], v[132:135], v[156:159]
    v_mfma_f32_16x16x32_bf16 v[144:147], v[80:83], v[132:135], v[144:147]
    v_mfma_f32_16x16x32_bf16 v[152:155], v[108:111], v[132:135], v[152:155]
    v_mfma_f32_16x16x32_bf16 v[148:151], v[92:95], v[136:139], v[148:151]
    v_mfma_f32_16x16x32_bf16 v[156:159], v[120:123], v[136:139], v[156:159]
    v_mfma_f32_16x16x32_bf16 v[144:147], v[88:91], v[136:139], v[144:147]
    v_mfma_f32_16x16x32_bf16 v[152:155], v[116:119], v[136:139], v[152:155]
    v_mfma_f32_16x16x32_bf16 v[144:147], v[96:99], v[140:143], v[144:147]
    v_mfma_f32_16x16x32_bf16 v[152:155], v[124:127], v[140:143], v[152:155]
    s_nop 6
    v_add_f32_dpp v160, v148, v144 row_ror:8 row_mask:0xf bank_mask:0x3
    v_add_f32_dpp v161, v149, v145 row_ror:8 row_mask:0xf bank_mask:0x3
    v_add_f32_dpp v162, v150, v146 row_ror:8 row_mask:0xf bank_mask:0x3
    v_add_f32_dpp v163, v151, v147 row_ror:8 row_mask:0xf bank_mask:0x3
    v_add_f32_dpp v160, v152, v156 row_ror:8 row_mask:0xf bank_mask:0xc
    v_add_f32_dpp v161, v153, v157 row_ror:8 row_mask:0xf bank_mask:0xc
    v_add_f32_dpp v162, v154, v158 row_ror:8 row_mask:0xf bank_mask:0xc
    v_add_f32_dpp v163, v155, v159 row_ror:8 row_mask:0xf bank_mask:0xc
    v_and_or_b32 v160, v160, -16, v64
    v_and_or_b32 v161, v161, -16, v65
    v_and_or_b32 v162, v162, -16, v66
    v_and_or_b32 v163, v163, -16, v67
    buffer_store_dwordx4 v[160:163], v54, s[60:63], s69 offen sc1
    buffer_store_dwordx4 v[160:163], v54, s[60:63], s70 offen sc1
L_fin:
    s_mov_b64 exec, -1
L_end:
    s_endpgm
L_ls1:
    buffer_store_dwordx4 v[24:27], v22, s[60:63], s70 offen sc1
    s_branch L_le1
L_ls2:
    buffer_store_dword v15, v14, s[60:63], s38 offen offset:128 sc1
    s_branch L_le2
L_ls3:
    buffer_store_dword v128, v50, s[60:63], s82 offen sc1
    s_branch L_le3
L_ls4:
    buffer_store_dword v160, v104, s[60:63], s70 offen sc1
    s_branch L_le4
L_ls5:
    buffer_store_dword v192, v59, s[64:67], s70 offen sc1
    s_branch L_le5
.section .rodata,"a"
.p2align 6
.amdhsa_kernel sequential_preLN__sliding_block_cached__moe_arch_mod__decode_kernel
.amdhsa_next_free_vgpr 256
.amdhsa_next_free_sgpr 102
.amdhsa_accum_offset 256
.amdhsa_group_segment_fixed_size 0
.amdhsa_kernarg_size 104
.amdhsa_user_sgpr_count 2
.amdhsa_user_sgpr_kernarg_segment_ptr 1
.amdhsa_system_sgpr_workgroup_id_x 1
.amdhsa_float_denorm_mode_32 3
.end_amdhsa_kernel
```
